```python
import torch

def _softmax(x, axis=-1):
    return torch.softmax(x, dim=axis)
def _gelu(x):
    return torch.nn.functional.gelu(x, approximate="tanh")
def _silu(x):
    return torch.nn.functional.silu(x)
def _sigmoid(x):
    return torch.sigmoid(x)
def _layernorm(x, axis=-1, eps=1e-5):
    m = x.mean(dim=axis, keepdim=True)
    v = x.var(dim=axis, keepdim=True, unbiased=False)
    return (x - m) / torch.sqrt(v + eps)
def _scatter_add(tgt, idx, src, axis=0):
    return tgt.clone().index_add_(axis, idx, src)
def _segment_sum(src, seg, n):
    out = torch.zeros((n,) + src.shape[1:], dtype=src.dtype)
    return out.index_add_(0, seg, src)
def _pad(x, pw):
    flat = tuple(v for pair in reversed(pw) for v in pair)
    return torch.nn.functional.pad(x, flat)

kernel_name = 'gated_mix__ssm_conv_h3__dense_activation_relu__prompt'

def setup_inputs():

    _w = (lambda a: (lambda t: t.to(torch.bfloat16) if t.is_floating_point() else t)(torch.as_tensor(a)))
    def _A_setup():
        B, S, D = 1, 2048, 1024
        ks = 4
        return {
            "q": _w((lambda *s: torch.randn(*s, dtype=torch.bfloat16) * 0.05)(B, S, D)),
            "k": _w((lambda *s: torch.randn(*s, dtype=torch.bfloat16) * 0.8)(B, S, D)),
            "v": _w((lambda *s: torch.randn(*s, dtype=torch.bfloat16) * 0.8)(B, S, D)),
            "shift_k": _w((lambda *s: torch.randn(*s, dtype=torch.bfloat16) * 0.8)(D, ks) * 0.5),
            "ssm_k": _w((lambda *s: torch.randn(*s, dtype=torch.bfloat16) * 0.8)(D, S) * (1.0 / S ** 0.5)),
            "ssm_D": _w((lambda *s: torch.randn(*s, dtype=torch.bfloat16) * 0.8)(D)),
        }
    _A_in = _A_setup()

    def _B_setup():
        B, S, D, Dff = 1, 2048, 1024, 3584
        return {
            "x": _w((lambda *s: torch.randn(*s, dtype=torch.bfloat16) * 0.05)(B, S, D)),
            "w1": _w((lambda *s: torch.randn(*s, dtype=torch.bfloat16) * 0.05)(D, Dff)),
            "w2": _w((lambda *s: torch.randn(*s, dtype=torch.bfloat16) * 0.05)(Dff, D)),
        }
    _B_in = _B_setup()

    return {
        "A_q": _A_in["q"],
        "A_k": _A_in["k"],
        "A_v": _A_in["v"],
        "A_shift_k": _A_in["shift_k"],
        "A_ssm_k": _A_in["ssm_k"],
        "A_ssm_D": _A_in["ssm_D"],
        "B_x": _B_in["x"],
        "B_w1": _B_in["w1"],
        "B_w2": _B_in["w2"],
        "gate_w": _w((lambda *s: torch.randn(*s, dtype=torch.bfloat16) * 0.05)(1024) * 16.0),
    }

def reference(A_q, A_k, A_v, A_shift_k, A_ssm_k, A_ssm_D, B_x, B_w1, B_w2, gate_w):
    def _A_ref(q, k, v, shift_k, ssm_k, ssm_D):
        B, S, D = q.shape
        ks = shift_k.shape[-1]
        k_pad = _pad(k, ((0, 0), (ks - 1, 0), (0, 0)))
        k_shift = torch.zeros_like(k)
        for t in range(ks):
            k_shift = k_shift + k_pad[:, t:t + S, :] * shift_k[:, ks - 1 - t][None, None, :]
        kv = k_shift * v
        L = 2 * S
        kv_pad = _pad(kv, ((0, 0), (0, S), (0, 0)))
        kf_pad = _pad(ssm_k, ((0, 0), (0, S)))
        kv_f = (lambda x, axes=(-2,-1): torch.fft.rfft2(x.float(), dim=axes))(kv_pad[:, None, :, :], axes=(1, 2))
        kf_f = (lambda x, axes=(-2,-1): torch.fft.rfft2(x.float(), dim=axes))(kf_pad[:, None, :], axes=(1, 2))
        kf_f = (lambda x, *d: x.permute(*d))(kf_f, 1, 2, 0)
        y_f = kv_f * kf_f[None, :, :, :]
        y = (lambda x, s, axes=(-2,-1): torch.fft.irfft2(x, s=s, dim=axes).to(torch.bfloat16))(y_f, (1, L), axes=(1, 2))[:, 0, :S, :]
        y = y + kv * ssm_D[None, None, :]
        return q * y

    def _B_ref(x, w1, w2):
        h = torch.einsum("bsd,df->bsf", x, w1)
        zero = torch.zeros_like(h)
        h = torch.maximum(h, zero)
        return torch.einsum("bsf,fd->bsd", h, w2)

    x = A_q
    g = _sigmoid((x * gate_w).sum(-1, keepdims=True))
    a = _A_ref(x, A_k, A_v, A_shift_k, A_ssm_k, A_ssm_D)
    b = _B_ref(x, B_w1, B_w2)
    return g * a + (1 - g) * b
```

```asm
; @launch grid=(256,1,1) block=(512,1,1) lds=163840
.amdgcn_target "amdgcn-amd-amdhsa--gfx950"
.text
.globl gated_mix__ssm_conv_h3__dense_activation_relu__prompt_kernel
.p2align 8
.type gated_mix__ssm_conv_h3__dense_activation_relu__prompt_kernel,@function
gated_mix__ssm_conv_h3__dense_activation_relu__prompt_kernel:
    s_load_dwordx16 s[64:79], s[0:1], 0
    s_load_dwordx8 s[80:87], s[0:1], 64
    s_load_dwordx2 s[88:89], s[0:1], 96
    s_cmp_ge_u32 s2, 256
    s_cbranch_scc1 L_end
    v_lshrrev_b32 v1, 6, v0
    v_mov_b32 v4, v0
    v_and_b32 v0, 63, v0
    v_readfirstlane_b32 s4, v1
    s_and_b32 s5, s2, 7
    s_lshr_b32 s6, s2, 3
    s_and_b32 s56, s2, 1
    s_and_b32 s55, s6, 7
    s_cmp_lt_u32 s55, 6
    s_cselect_b32 s95, 1, 0
    s_andn2_b32 s95, s95, s56
    s_xor_b32 s95, s95, s55
    s_mul_i32 s53, s56, 7
    s_add_u32 s53, s53, s95
    s_lshr_b32 s57, s2, 6
    s_lshr_b32 s59, s5, 1
    s_lshl2_add_u32 s54, s59, s57
    s_and_b32 s7, s4, 3
    s_cmp_ge_u32 s4, 4
    s_cbranch_scc1 L_lwave
    s_getpc_b64 s[90:91]
L_pc:
    v_lshlrev_b32 v2, 7, v4
    v_mov_b32 v5, s91
    v_min_u32 v3, L_end-L_pc, v2
    v_add_co_u32 v6, vcc, s90, v3
    s_nop 1
    v_addc_co_u32 v7, vcc, 0, v5, vcc
    global_load_dword v119, v[6:7], off
    s_branch L_cwave
L_lwave:
    s_cmp_eq_u32 s55, 7
    s_cbranch_scc1 L_prep
    v_lshrrev_b32 v1, 3, v0
    v_lshrrev_b32 v2, 4, v0
    v_and_b32 v3, 7, v0
    v_xor_b32 v3, v3, v2
    v_lshlrev_b32 v3, 4, v3
    v_lshl_add_u32 v8, v1, 11, v3
    v_xor_b32 v4, 64, v8
    v_add_u32 v9, 15360, v4
    v_add_u32 v10, 30720, v8
    v_add_u32 v11, 46080, v4
    s_lshl1_add_u32 s59, s56, s59
    s_and_b32 s3, s53, 1
    s_mul_i32 s3, s3, 4
    s_lshl2_add_u32 s59, s59, s3
    s_and_b32 s59, s59, 15
    s_lshl2_add_u32 s57, s54, s7
    s_lshl_b32 s57, s57, 16
    s_lshl_b32 s63, s7, 12
    s_mov_b32 s60, 49152
    s_lshl_b32 s61, s59, 7
    s_add_u32 s61, s61, s57
    s_add_u32 m0, s60, s63
    v_lshrrev_b32 v1, 5, v0
    v_and_b32 v2, 31, v0
    v_lshlrev_b32 v3, 1, v1
    v_xor_b32 v2, v2, v3
    v_mul_u32_u24 v1, 7168, v1
    v_lshl_add_u32 v12, v2, 4, v1
    v_xor_b32 v1, 64, v12
    v_xor_b32 v2, 128, v12
    v_xor_b32 v3, 64, v2
    v_add_u32 v13, 13312, v1
    v_add_u32 v14, 26624, v12
    v_add_u32 v15, 39936, v1
    v_add_u32 v16, 57344, v2
    v_add_u32 v17, 70656, v3
    v_add_u32 v18, 83968, v2
    v_add_u32 v19, 97280, v3
    s_mul_i32 s58, s7, 224
    s_add_u32 s58, s58, s53
    s_lshl_b32 s58, s58, 9
    s_lshl1_add_u32 s90, s63, 16384
    s_mov_b32 s92, -2
    s_waitcnt lgkmcnt(0)
    s_mov_b64 s[8:9], s[64:65]
    s_mov_b32 s10, 0x400000
    s_mov_b32 s11, 0x20000
    s_mov_b64 s[12:13], s[78:79]
    s_mov_b32 s14, 0x700000
    s_mov_b32 s15, 0x20000
    buffer_load_dwordx4 v8, s[8:11], s61 offen offset:0 lds
    buffer_load_dwordx4 v9, s[8:11], s61 offen offset:1024 lds
    buffer_load_dwordx4 v10, s[8:11], s61 offen offset:2048 lds
    buffer_load_dwordx4 v11, s[8:11], s61 offen offset:3072 lds
    s_add_u32 m0, s60, s90
    s_mul_i32 s62, s59, 458752
    s_add_u32 s62, s62, s58
    buffer_load_dwordx4 v12, s[12:15], s62 offen offset:0 lds
    buffer_load_dwordx4 v13, s[12:15], s62 offen offset:1024 lds
    buffer_load_dwordx4 v14, s[12:15], s62 offen offset:2048 lds
    buffer_load_dwordx4 v15, s[12:15], s62 offen offset:3072 lds
    s_lshl_b32 s76, s5, 5
    s_add_u32 s76, s76, s6
    s_lshl_b32 s76, s76, 2
    s_add_u32 s76, s76, s7
    s_lshr_b32 s3, s76, 1
    s_lshl_b32 s3, s3, 2
    s_load_dword s93, s[74:75], s3
    s_lshl_b32 s3, s76, 12
    s_load_dword s51, s[72:73], s3
    s_add_u32 m0, m0, 0x1000
    s_add_u32 s59, s59, 1
    s_and_b32 s59, s59, 15
    s_lshl_b32 s61, s59, 7
    s_add_u32 s61, s61, s57
    s_add_u32 s60, s60, 49152
    s_cmp_eq_u32 s60, 147456
    s_cselect_b32 s60, 0, s60
    s_add_u32 s92, s92, 1
    buffer_load_dwordx4 v16, s[12:15], s62 offen offset:0 lds
    buffer_load_dwordx4 v17, s[12:15], s62 offen offset:1024 lds
    buffer_load_dwordx4 v18, s[12:15], s62 offen offset:2048 lds
    buffer_load_dwordx4 v19, s[12:15], s62 offen offset:3072 lds
    s_add_u32 m0, s60, s63
L_warm_begin:
    v_mov_b32 v252, 0
    v_mov_b32 v253, 1
    s_mov_b64 s[20:21], s[88:89]
    s_mov_b32 s22, 0x10000000
    s_mov_b32 s23, 0x20000
    s_setprio 1
    v_lshlrev_b32 v1, 4, v0
    v_and_b32 v20, 31, v0
    v_lshlrev_b32 v20, 2, v20
    v_and_b32 v21, 15, v0
    v_lshlrev_b32 v21, 14, v21
    v_lshrrev_b32 v4, 4, v0
    v_and_b32 v2, 15, v0
    v_lshlrev_b32 v3, 1, v4
    v_xor_b32 v2, v2, v3
    v_lshlrev_b32 v2, 4, v2
    v_lshl_add_u32 v2, v4, 11, v2
    v_xor_b32 v3, 128, v2
    v_add_u32 v212, 0, v2
    v_add_u32 v213, 7168, v3
    v_add_u32 v214, 14336, v2
    v_add_u32 v215, 21504, v3
    v_and_b32 v2, 15, v0
    v_lshrrev_b32 v3, 4, v0
    s_lshl_b32 s94, s7, 14
    s_add_u32 s94, s94, 98304
    v_lshl_add_u32 v4, v3, 3, v2
    v_and_b32 v5, 1, v2
    v_add_u32 v6, v4, v5
    v_lshlrev_b32 v6, 1, v6
    v_xor_b32 v5, 1, v5
    v_mul_u32_u24 v5, 4160, v5
    v_add3_u32 v196, v6, v5, s94
    v_add_u32 v197, 1024, v196
    v_add_u32 v198, 2048, v196
    v_add_u32 v199, 3072, v196
    v_lshlrev_b32 v6, 4, v3
    v_lshlrev_b32 v5, 5, v2
    v_sub_u32 v6, v6, v5
    s_add_u32 s94, s94, 8800
    v_add_u32 v200, s94, v6
    v_and_b32 v201, 1, v3
    v_lshlrev_b32 v201, 9, v201
    v_lshrrev_b32 v5, 1, v3
    v_lshl_add_u32 v201, v5, 6, v201
    v_lshrrev_b32 v5, 2, v2
    v_lshl_add_u32 v201, v5, 7, v201
    v_and_b32 v5, 3, v0
    v_lshl_add_u32 v201, v5, 4, v201
    v_sub_u32 v4, 15, v4
    v_ashrrev_i32 v5, 1, v4
    v_and_b32 v4, 1, v4
    v_lshlrev_b32 v4, 4, v4
    s_waitcnt lgkmcnt(0)
    s_and_b32 s3, s76, 1
    s_lshl_b32 s3, s3, 4
    s_lshr_b32 s94, s93, s3
    s_and_b32 s94, s94, 0xffff
    v_lshlrev_b32 v4, v4, s94
    v_cmp_eq_u32 vcc, 0, v5
    s_nop 1
    v_cndmask_b32 v192, 0, v4, vcc
    v_cmp_eq_u32 vcc, 1, v5
    s_nop 1
    v_cndmask_b32 v193, 0, v4, vcc
    v_cmp_eq_u32 vcc, 2, v5
    s_nop 1
    v_cndmask_b32 v194, 0, v4, vcc
    v_cmp_eq_u32 vcc, 3, v5
    s_nop 1
    v_cndmask_b32 v195, 0, v4, vcc
    s_lshl_b32 s76, s76, 12
    s_add_u32 s76, s76, 0x1400000
    v_add_u32 v216, 12416, v1
    v_add_u32 v217, 2, v1
    s_movk_i32 s3, 0
    v_writelane_b32 v216, s3, 30
    s_movk_i32 s3, 16
    v_writelane_b32 v216, s3, 31
    s_movk_i32 s3, 4160
    v_writelane_b32 v216, s3, 32
    s_movk_i32 s3, 4176
    v_writelane_b32 v216, s3, 33
    s_lshl_b32 s94, s7, 14
    s_add_u32 s94, s94, 98304
    v_add_u32 v216, s94, v216
    v_add_u32 v217, s94, v1
    v_mov_b32 v220, 0
    v_mov_b32 v221, 0
    v_mov_b32 v222, 0
    v_mov_b32 v223, 0
    s_lshl_b32 s3, s51, 16
    v_writelane_b32 v223, s3, 33
    s_mov_b64 s[40:41], s[72:73]
    s_mov_b32 s42, 0x400000
    s_mov_b32 s43, 0x20000
    s_andn2_b32 s3, 1, s55
    s_mul_i32 s3, s3, 3
    s_add_u32 s3, s3, 0
    v_add_u32 v2, s3, v0
    v_subrev_u32 v3, 28, v2
    v_min_u32 v2, v2, v3
    s_lshr_b32 s3, s55, 1
    s_add_u32 s3, s54, s3
    v_add_u32 v3, s3, v2
    v_and_b32 v3, 3, v3
    v_and_b32 v2, 28, v2
    s_lshr_b32 s3, s54, 2
    s_mul_i32 s3, s3, 8
    v_add3_u32 v2, v2, v3, s3
    v_cmp_gt_u32 vcc, 28, v0
    v_subrev_u32 v3, 28, v2
    v_min_u32 v2, v2, v3
    v_cndmask_b32 v23, v0, v2, vcc
    s_mul_i32 s3, s56, 1
    s_lshl_b32 s52, s3, 1
    s_sub_u32 s52, 29, s52
    v_cmp_le_u32 vcc, s3, v23
    v_mov_b32 v3, 63
    s_nop 0
    v_mbcnt_lo_u32_b32 v2, vcc_lo, 0
    v_mbcnt_hi_u32_b32 v2, vcc_hi, v2
    v_cndmask_b32 v2, v3, v2, vcc
    v_lshlrev_b32 v2, 2, v2
    ds_permute_b32 v23, v2, v23
    s_waitcnt lgkmcnt(0)
    v_mov_b32 v2, 163456
    ds_write_b32 v2, v252
    s_waitcnt lgkmcnt(0)
    v_mov_b32 v24, 0
    v_mov_b32 v25, 0
    v_mov_b32 v26, 0
    s_mov_b32 s99, 0
    s_mov_b32 s91, 0x3140
    s_branch L_g1l_issue
L_g1l_loop:
    s_waitcnt vmcnt(12)
L_g1l_bar:
    s_barrier
L_g1l_issue:
    buffer_load_dwordx4 v8, s[8:11], s61 offen offset:0 lds
    buffer_load_dwordx4 v9, s[8:11], s61 offen offset:1024 lds
    buffer_load_dwordx4 v10, s[8:11], s61 offen offset:2048 lds
    buffer_load_dwordx4 v11, s[8:11], s61 offen offset:3072 lds
    s_add_u32 m0, s60, s90
    s_mul_i32 s62, s59, 458752
    s_add_u32 s62, s62, s58
    buffer_load_dwordx4 v12, s[12:15], s62 offen offset:0 lds
    buffer_load_dwordx4 v13, s[12:15], s62 offen offset:1024 lds
    buffer_load_dwordx4 v14, s[12:15], s62 offen offset:2048 lds
    buffer_load_dwordx4 v15, s[12:15], s62 offen offset:3072 lds
    s_add_u32 m0, m0, 0x1000
    s_add_u32 s59, s59, 1
    s_and_b32 s59, s59, 15
    s_lshl_b32 s61, s59, 7
    s_add_u32 s61, s61, s57
    s_add_u32 s60, s60, 49152
    s_cmp_eq_u32 s60, 147456
    s_cselect_b32 s60, 0, s60
    s_add_u32 s92, s92, 1
    buffer_load_dwordx4 v16, s[12:15], s62 offen offset:0 lds
    buffer_load_dwordx4 v17, s[12:15], s62 offen offset:1024 lds
    buffer_load_dwordx4 v18, s[12:15], s62 offen offset:2048 lds
    buffer_load_dwordx4 v19, s[12:15], s62 offen offset:3072 lds
    s_add_u32 m0, s60, s63
    s_bitcmp1_b32 s91, s92
    s_cbranch_scc1 L_g1l_event
    s_cmp_lt_i32 s92, 14
    s_cbranch_scc1 L_g1l_loop
    s_lshl_b32 s57, s5, 5
    s_add_u32 s57, s57, s6
    s_lshl_b32 s57, s57, 2
    s_add_u32 s57, s57, s7
    s_lshl_b32 s57, s57, 12
    s_lshl_b32 s58, s7, 14
    s_add_u32 s58, s58, 98304
    s_getreg_b32 s94, hwreg(HW_REG_XCC_ID, 0, 4)
    s_add_u32 s94, s94, 1
    s_waitcnt vmcnt(12)
    v_cmp_ne_u32 vcc, s94, v25
    v_mov_b32 v2, 163456
    s_cmp_ge_u32 s99, 32
    s_cselect_b32 s94, 1, 0
    s_cmp_eq_u32 vcc_lo, 0
    s_cselect_b32 s94, s94, 0
    v_mov_b32 v27, s94
    ds_write_b32 v2, v27
    v_cmp_ne_u32 vcc, 1, v26
    s_waitcnt lgkmcnt(0)
    s_barrier
    s_cmp_ge_u32 s99, 32
    s_cselect_b32 s92, vcc_lo, 1
    s_cmp_lg_u32 s92, 0
    s_cbranch_scc1 L_g1l_late
    s_add_u32 m0, s58, 32
    s_mov_b32 exec_hi, 3
    ds_write_b128 v216, v[220:223]
    s_mov_b64 exec, -1
    buffer_load_dwordx4 v1, s[40:43], s57 offen offset:0 lds
    buffer_load_dwordx4 v1, s[40:43], s57 offen offset:1024 lds
    buffer_load_dwordx4 v1, s[40:43], s57 offen offset:2048 lds
    buffer_load_dwordx4 v1, s[40:43], s57 offen offset:3072 lds
    s_add_u32 m0, s58, 8320
    s_add_u32 s3, s57, 0x1000000
    buffer_load_dwordx4 v1, s[20:23], s3 offen offset:0 sc1 lds
    buffer_load_dwordx4 v1, s[20:23], s3 offen offset:1024 sc1 lds
    buffer_load_dwordx4 v1, s[20:23], s3 offen offset:2048 sc1 lds
    buffer_load_dwordx4 v1, s[20:23], s3 offen offset:3072 sc1 lds
    s_waitcnt vmcnt(8)
    s_barrier
L_conv_l:
    s_mov_b64 s[16:17], s[80:81]
    s_mov_b32 s18, 0x700000
    s_mov_b32 s19, 0x20000
    s_mul_i32 s57, s54, 917504
    s_mul_i32 s3, s56, 458752
    s_add_u32 s57, s57, s3
    s_lshl_b32 s63, s7, 12
    s_add_u32 s57, s57, s63
    s_mul_i32 s58, s56, 3670016
    s_lshl_b32 s3, s55, 8
    s_add_u32 s58, s58, s3
    s_lshl_b32 s3, s7, 15
    s_add_u32 s58, s58, s3
    s_mov_b32 s59, 0
    v_readlane_b32 s93, v23, s59
    s_add_u32 s59, s59, 1
    s_add_u32 m0, s63, 0
    s_lshl_b32 s62, s93, 17
    s_add_u32 s62, s62, s58
    buffer_load_dwordx4 v212, s[16:19], s62 offen offset:0 lds
    buffer_load_dwordx4 v213, s[16:19], s62 offen offset:1024 lds
    buffer_load_dwordx4 v214, s[16:19], s62 offen offset:2048 lds
    buffer_load_dwordx4 v215, s[16:19], s62 offen offset:3072 lds
    v_readlane_b32 s93, v23, s59
    s_add_u32 s59, s59, 1
    v_readlane_b32 s93, v23, s59
    s_add_u32 s59, s59, 1
    v_readlane_b32 s93, v23, s59
    s_add_u32 s59, s59, 1
    s_lshl_b32 s61, s93, 14
    s_add_u32 s61, s61, s57
    s_lshl_b32 s91, s55, 10
    s_add_u32 s91, s91, 0x2040280
    s_lshl_b32 s60, s54, 1
    s_add_u32 s60, s60, s56
    s_mov_b32 s90, 0x2040280
    s_waitcnt vmcnt(8)
    ds_read_b128 v[224:227], v217 offset:32
    ds_read_b32 v240, v217 offset:48
    ds_read_b128 v[228:231], v217 offset:1056
    ds_read_b32 v241, v217 offset:1072
    ds_read_b128 v[232:235], v217 offset:2080
    ds_read_b32 v242, v217 offset:2096
    ds_read_b128 v[236:239], v217 offset:3104
    ds_read_b32 v243, v217 offset:3120
    s_waitcnt lgkmcnt(6)
    v_alignbit_b32 v224, v225, v224, 16
    v_alignbit_b32 v225, v226, v225, 16
    v_alignbit_b32 v226, v227, v226, 16
    v_alignbit_b32 v227, v240, v227, 16
    ds_write_b128 v217, v[224:227] offset:4192
    s_waitcnt lgkmcnt(5)
    v_alignbit_b32 v228, v229, v228, 16
    v_alignbit_b32 v229, v230, v229, 16
    v_alignbit_b32 v230, v231, v230, 16
    v_alignbit_b32 v231, v241, v231, 16
    ds_write_b128 v217, v[228:231] offset:5216
    s_waitcnt lgkmcnt(4)
    v_alignbit_b32 v232, v233, v232, 16
    v_alignbit_b32 v233, v234, v233, 16
    v_alignbit_b32 v234, v235, v234, 16
    v_alignbit_b32 v235, v242, v235, 16
    ds_write_b128 v217, v[232:235] offset:6240
    s_waitcnt lgkmcnt(3)
    v_alignbit_b32 v236, v237, v236, 16
    v_alignbit_b32 v237, v238, v237, 16
    v_alignbit_b32 v238, v239, v238, 16
    v_alignbit_b32 v239, v243, v239, 16
    ds_write_b128 v217, v[236:239] offset:7264
    s_setprio 0
    s_waitcnt vmcnt(4) lgkmcnt(0)
    ds_read_b128 v[96:99], v200 offset:3584
    ds_read_b128 v[100:103], v200 offset:3072
    ds_read_b128 v[104:107], v200 offset:2560
    ds_read_b128 v[108:111], v200 offset:2048
    ds_read_b128 v[112:115], v200 offset:1536
    ds_read_b128 v[116:119], v200 offset:1024
    ds_read_b128 v[120:123], v200 offset:512
    ds_read_b128 v[124:127], v200 offset:0
    ds_read2_b32 v[32:33], v196 offset0:0 offset1:1
    ds_read2_b32 v[34:35], v196 offset0:2 offset1:3
    ds_read2_b32 v[36:37], v196 offset0:128 offset1:129
    ds_read2_b32 v[38:39], v196 offset0:130 offset1:131
    ds_read2_b32 v[40:41], v197 offset0:0 offset1:1
    ds_read2_b32 v[42:43], v197 offset0:2 offset1:3
    ds_read2_b32 v[44:45], v197 offset0:128 offset1:129
    ds_read2_b32 v[46:47], v197 offset0:130 offset1:131
    ds_read2_b32 v[48:49], v198 offset0:0 offset1:1
    ds_read2_b32 v[50:51], v198 offset0:2 offset1:3
    ds_read2_b32 v[52:53], v198 offset0:128 offset1:129
    ds_read2_b32 v[54:55], v198 offset0:130 offset1:131
    ds_read2_b32 v[56:57], v199 offset0:0 offset1:1
    ds_read2_b32 v[58:59], v199 offset0:2 offset1:3
    ds_read2_b32 v[60:61], v199 offset0:128 offset1:129
    ds_read2_b32 v[62:63], v199 offset0:130 offset1:131
    s_waitcnt lgkmcnt(15)
    v_mfma_f32_16x16x32_bf16 v[160:163], v[192:195], v[96:99], 0
    v_mfma_f32_16x16x32_bf16 v[164:167], v[192:195], v[100:103], 0
    v_mfma_f32_16x16x32_bf16 v[168:171], v[192:195], v[104:107], 0
    v_mfma_f32_16x16x32_bf16 v[172:175], v[192:195], v[108:111], 0
    v_mfma_f32_16x16x32_bf16 v[176:179], v[192:195], v[112:115], 0
    v_mfma_f32_16x16x32_bf16 v[180:183], v[192:195], v[116:119], 0
    v_mfma_f32_16x16x32_bf16 v[184:187], v[192:195], v[120:123], 0
    v_mfma_f32_16x16x32_bf16 v[188:191], v[192:195], v[124:127], 0
    s_waitcnt lgkmcnt(0)
    s_mov_b32 s92, 0
    s_branch L_cv_entry
L_cv_loop:
    v_mfma_f32_16x16x32_bf16 v[160:163], v[64:67], v[128:131], v[160:163]
    v_add_u32 v200, 64, v200
    v_mfma_f32_16x16x32_bf16 v[164:167], v[64:67], v[132:135], v[164:167]
    v_add_u32 v196, 64, v196
    v_mfma_f32_16x16x32_bf16 v[164:167], v[68:71], v[128:131], v[164:167]
    v_add_u32 v197, 64, v197
    v_mfma_f32_16x16x32_bf16 v[168:171], v[64:67], v[136:139], v[168:171]
    v_add_u32 v198, 64, v198
    v_mfma_f32_16x16x32_bf16 v[168:171], v[68:71], v[132:135], v[168:171]
    v_add_u32 v199, 64, v199
    v_mfma_f32_16x16x32_bf16 v[168:171], v[72:75], v[128:131], v[168:171]
    ds_read_b128 v[96:99], v200 offset:3584
    v_mfma_f32_16x16x32_bf16 v[172:175], v[64:67], v[140:143], v[172:175]
    ds_read2_b32 v[32:33], v196 offset0:0 offset1:1
    v_mfma_f32_16x16x32_bf16 v[172:175], v[68:71], v[136:139], v[172:175]
    ds_read2_b32 v[34:35], v196 offset0:2 offset1:3
    v_mfma_f32_16x16x32_bf16 v[172:175], v[72:75], v[132:135], v[172:175]
    ds_read_b128 v[100:103], v200 offset:3072
    v_mfma_f32_16x16x32_bf16 v[172:175], v[76:79], v[128:131], v[172:175]
    v_mfma_f32_16x16x32_bf16 v[176:179], v[64:67], v[144:147], v[176:179]
    ds_read2_b32 v[36:37], v196 offset0:128 offset1:129
    v_mfma_f32_16x16x32_bf16 v[176:179], v[68:71], v[140:143], v[176:179]
    ds_read2_b32 v[38:39], v196 offset0:130 offset1:131
    v_mfma_f32_16x16x32_bf16 v[176:179], v[72:75], v[136:139], v[176:179]
    ds_read_b128 v[104:107], v200 offset:2560
    v_mfma_f32_16x16x32_bf16 v[176:179], v[76:79], v[132:135], v[176:179]
    ds_read2_b32 v[40:41], v197 offset0:0 offset1:1
    v_mfma_f32_16x16x32_bf16 v[176:179], v[80:83], v[128:131], v[176:179]
    s_waitcnt lgkmcnt(8)
    v_mfma_f32_16x16x32_bf16 v[180:183], v[64:67], v[148:151], v[180:183]
    ds_read2_b32 v[42:43], v197 offset0:2 offset1:3
    v_mfma_f32_16x16x32_bf16 v[180:183], v[68:71], v[144:147], v[180:183]
    ds_read_b128 v[108:111], v200 offset:2048
    v_mfma_f32_16x16x32_bf16 v[180:183], v[72:75], v[140:143], v[180:183]
    ds_read2_b32 v[44:45], v197 offset0:128 offset1:129
    v_mfma_f32_16x16x32_bf16 v[180:183], v[76:79], v[136:139], v[180:183]
    ds_read2_b32 v[46:47], v197 offset0:130 offset1:131
    v_mfma_f32_16x16x32_bf16 v[180:183], v[80:83], v[132:135], v[180:183]
    v_mfma_f32_16x16x32_bf16 v[180:183], v[84:87], v[128:131], v[180:183]
    ds_read_b128 v[112:115], v200 offset:1536
    v_mfma_f32_16x16x32_bf16 v[184:187], v[64:67], v[152:155], v[184:187]
    ds_read2_b32 v[48:49], v198 offset0:0 offset1:1
    v_mfma_f32_16x16x32_bf16 v[184:187], v[68:71], v[148:151], v[184:187]
    ds_read2_b32 v[50:51], v198 offset0:2 offset1:3
    v_mfma_f32_16x16x32_bf16 v[184:187], v[72:75], v[144:147], v[184:187]
    ds_read_b128 v[116:119], v200 offset:1024
    v_mfma_f32_16x16x32_bf16 v[184:187], v[76:79], v[140:143], v[184:187]
    v_mfma_f32_16x16x32_bf16 v[184:187], v[80:83], v[136:139], v[184:187]
    ds_read2_b32 v[52:53], v198 offset0:128 offset1:129
    v_mfma_f32_16x16x32_bf16 v[184:187], v[84:87], v[132:135], v[184:187]
    ds_read2_b32 v[54:55], v198 offset0:130 offset1:131
    v_mfma_f32_16x16x32_bf16 v[184:187], v[88:91], v[128:131], v[184:187]
    ds_read_b128 v[120:123], v200 offset:512
    v_mfma_f32_16x16x32_bf16 v[188:191], v[64:67], v[156:159], v[188:191]
    ds_read2_b32 v[56:57], v199 offset0:0 offset1:1
    v_mfma_f32_16x16x32_bf16 v[188:191], v[68:71], v[152:155], v[188:191]
    v_mfma_f32_16x16x32_bf16 v[188:191], v[72:75], v[148:151], v[188:191]
    ds_read2_b32 v[58:59], v199 offset0:2 offset1:3
    v_mfma_f32_16x16x32_bf16 v[188:191], v[76:79], v[144:147], v[188:191]
    ds_read_b128 v[124:127], v200 offset:0
    v_mfma_f32_16x16x32_bf16 v[188:191], v[80:83], v[140:143], v[188:191]
    ds_read2_b32 v[60:61], v199 offset0:128 offset1:129
    v_mfma_f32_16x16x32_bf16 v[188:191], v[84:87], v[136:139], v[188:191]
    ds_read2_b32 v[62:63], v199 offset0:130 offset1:131
    v_mfma_f32_16x16x32_bf16 v[188:191], v[88:91], v[132:135], v[188:191]
    v_mfma_f32_16x16x32_bf16 v[188:191], v[92:95], v[128:131], v[188:191]
    s_waitcnt lgkmcnt(9)
L_cv_entry:
    v_mfma_f32_16x16x32_bf16 v[160:163], v[32:35], v[96:99], v[160:163]
    v_add_u32 v200, 64, v200
    v_mfma_f32_16x16x32_bf16 v[164:167], v[32:35], v[100:103], v[164:167]
    v_add_u32 v196, 64, v196
    v_mfma_f32_16x16x32_bf16 v[164:167], v[36:39], v[96:99], v[164:167]
    v_add_u32 v197, 64, v197
    v_mfma_f32_16x16x32_bf16 v[168:171], v[32:35], v[104:107], v[168:171]
    v_add_u32 v198, 64, v198
    v_mfma_f32_16x16x32_bf16 v[168:171], v[36:39], v[100:103], v[168:171]
    v_add_u32 v199, 64, v199
    v_mfma_f32_16x16x32_bf16 v[168:171], v[40:43], v[96:99], v[168:171]
    ds_read_b128 v[128:131], v200 offset:3584
    v_mfma_f32_16x16x32_bf16 v[172:175], v[32:35], v[108:111], v[172:175]
    ds_read2_b32 v[64:65], v196 offset0:0 offset1:1
    v_mfma_f32_16x16x32_bf16 v[172:175], v[36:39], v[104:107], v[172:175]
    ds_read2_b32 v[66:67], v196 offset0:2 offset1:3
    v_mfma_f32_16x16x32_bf16 v[172:175], v[40:43], v[100:103], v[172:175]
    ds_read_b128 v[132:135], v200 offset:3072
    v_mfma_f32_16x16x32_bf16 v[172:175], v[44:47], v[96:99], v[172:175]
    v_mfma_f32_16x16x32_bf16 v[176:179], v[32:35], v[112:115], v[176:179]
    ds_read2_b32 v[68:69], v196 offset0:128 offset1:129
    v_mfma_f32_16x16x32_bf16 v[176:179], v[36:39], v[108:111], v[176:179]
    ds_read2_b32 v[70:71], v196 offset0:130 offset1:131
    v_mfma_f32_16x16x32_bf16 v[176:179], v[40:43], v[104:107], v[176:179]
    ds_read_b128 v[136:139], v200 offset:2560
    v_mfma_f32_16x16x32_bf16 v[176:179], v[44:47], v[100:103], v[176:179]
    ds_read2_b32 v[72:73], v197 offset0:0 offset1:1
    v_mfma_f32_16x16x32_bf16 v[176:179], v[48:51], v[96:99], v[176:179]
    s_waitcnt lgkmcnt(8)
    v_mfma_f32_16x16x32_bf16 v[180:183], v[32:35], v[116:119], v[180:183]
    ds_read2_b32 v[74:75], v197 offset0:2 offset1:3
    v_mfma_f32_16x16x32_bf16 v[180:183], v[36:39], v[112:115], v[180:183]
    ds_read_b128 v[140:143], v200 offset:2048
    v_mfma_f32_16x16x32_bf16 v[180:183], v[40:43], v[108:111], v[180:183]
    ds_read2_b32 v[76:77], v197 offset0:128 offset1:129
    v_mfma_f32_16x16x32_bf16 v[180:183], v[44:47], v[104:107], v[180:183]
    ds_read2_b32 v[78:79], v197 offset0:130 offset1:131
    v_mfma_f32_16x16x32_bf16 v[180:183], v[48:51], v[100:103], v[180:183]
    v_mfma_f32_16x16x32_bf16 v[180:183], v[52:55], v[96:99], v[180:183]
    ds_read_b128 v[144:147], v200 offset:1536
    v_mfma_f32_16x16x32_bf16 v[184:187], v[32:35], v[120:123], v[184:187]
    ds_read2_b32 v[80:81], v198 offset0:0 offset1:1
    v_mfma_f32_16x16x32_bf16 v[184:187], v[36:39], v[116:119], v[184:187]
    ds_read2_b32 v[82:83], v198 offset0:2 offset1:3
    v_mfma_f32_16x16x32_bf16 v[184:187], v[40:43], v[112:115], v[184:187]
    ds_read_b128 v[148:151], v200 offset:1024
    v_mfma_f32_16x16x32_bf16 v[184:187], v[44:47], v[108:111], v[184:187]
    v_mfma_f32_16x16x32_bf16 v[184:187], v[48:51], v[104:107], v[184:187]
    ds_read2_b32 v[84:85], v198 offset0:128 offset1:129
    v_mfma_f32_16x16x32_bf16 v[184:187], v[52:55], v[100:103], v[184:187]
    ds_read2_b32 v[86:87], v198 offset0:130 offset1:131
    v_mfma_f32_16x16x32_bf16 v[184:187], v[56:59], v[96:99], v[184:187]
    ds_read_b128 v[152:155], v200 offset:512
    v_mfma_f32_16x16x32_bf16 v[188:191], v[32:35], v[124:127], v[188:191]
    ds_read2_b32 v[88:89], v199 offset0:0 offset1:1
    v_mfma_f32_16x16x32_bf16 v[188:191], v[36:39], v[120:123], v[188:191]
    v_mfma_f32_16x16x32_bf16 v[188:191], v[40:43], v[116:119], v[188:191]
    ds_read2_b32 v[90:91], v199 offset0:2 offset1:3
    v_mfma_f32_16x16x32_bf16 v[188:191], v[44:47], v[112:115], v[188:191]
    ds_read_b128 v[156:159], v200 offset:0
    v_mfma_f32_16x16x32_bf16 v[188:191], v[48:51], v[108:111], v[188:191]
    ds_read2_b32 v[92:93], v199 offset0:128 offset1:129
    v_mfma_f32_16x16x32_bf16 v[188:191], v[52:55], v[104:107], v[188:191]
    s_add_u32 s92, s92, 1
    ds_read2_b32 v[94:95], v199 offset0:130 offset1:131
    v_mfma_f32_16x16x32_bf16 v[188:191], v[56:59], v[100:103], v[188:191]
    s_cmp_lt_u32 s92, 4
    v_mfma_f32_16x16x32_bf16 v[188:191], v[60:63], v[96:99], v[188:191]
    s_waitcnt lgkmcnt(9)
    s_cbranch_scc1 L_cv_loop
    v_mfma_f32_16x16x32_bf16 v[160:163], v[64:67], v[128:131], v[160:163]
    v_and_b32 v2, 15, v0
    v_lshrrev_b32 v3, 4, v0
    v_mfma_f32_16x16x32_bf16 v[164:167], v[64:67], v[132:135], v[164:167]
    v_xor_b32 v2, v2, v3
    v_lshlrev_b32 v2, 4, v2
    v_mfma_f32_16x16x32_bf16 v[164:167], v[68:71], v[128:131], v[164:167]
    v_lshl_add_u32 v2, v3, 11, v2
    v_xor_b32 v4, 0, v2
    v_mfma_f32_16x16x32_bf16 v[168:171], v[64:67], v[136:139], v[168:171]
    v_add_u32 v204, 0, v4
    v_xor_b32 v4, 64, v2
    v_mfma_f32_16x16x32_bf16 v[168:171], v[68:71], v[132:135], v[168:171]
    v_add_u32 v205, 7168, v4
    v_xor_b32 v4, 128, v2
    s_waitcnt lgkmcnt(0)
    v_mfma_f32_16x16x32_bf16 v[168:171], v[72:75], v[128:131], v[168:171]
    v_add_u32 v206, 14336, v4
    v_xor_b32 v4, 192, v2
    v_mfma_f32_16x16x32_bf16 v[172:175], v[64:67], v[140:143], v[172:175]
    v_add_u32 v207, 21504, v4
    v_lshrrev_b32 v4, 3, v0
    v_mfma_f32_16x16x32_bf16 v[172:175], v[68:71], v[136:139], v[172:175]
    v_and_b32 v2, 7, v0
    v_xor_b32 v2, v2, v3
    v_mfma_f32_16x16x32_bf16 v[172:175], v[72:75], v[132:135], v[172:175]
    v_lshlrev_b32 v2, 4, v2
    v_lshl_add_u32 v2, v4, 12, v2
    v_mfma_f32_16x16x32_bf16 v[172:175], v[76:79], v[128:131], v[172:175]
    v_add_u32 v208, 0, v2
    v_add_u32 v209, 31744, v2
    v_mfma_f32_16x16x32_bf16 v[176:179], v[64:67], v[144:147], v[176:179]
    v_cvt_pk_bf16_f32 v32, v160, v161
    v_cvt_pk_bf16_f32 v33, v162, v163
    v_mfma_f32_16x16x32_bf16 v[176:179], v[68:71], v[140:143], v[176:179]
    v_cvt_pk_bf16_f32 v34, v164, v165
    v_cvt_pk_bf16_f32 v35, v166, v167
    v_mfma_f32_16x16x32_bf16 v[176:179], v[72:75], v[136:139], v[176:179]
    v_add_u32 v210, 63488, v2
    v_add_u32 v211, 95232, v2
    v_mfma_f32_16x16x32_bf16 v[176:179], v[76:79], v[132:135], v[176:179]
    v_permlane16_swap_b32 v32, v34
    v_lshrrev_b32 v202, 1, v0
    v_mfma_f32_16x16x32_bf16 v[176:179], v[80:83], v[128:131], v[176:179]
    v_permlane16_swap_b32 v33, v35
    v_lshlrev_b32 v202, 13, v202
    v_mfma_f32_16x16x32_bf16 v[180:183], v[64:67], v[148:151], v[180:183]
    v_and_b32 v2, 1, v0
    v_lshl_add_u32 v202, v2, 3, v202
    v_mfma_f32_16x16x32_bf16 v[180:183], v[68:71], v[144:147], v[180:183]
    s_lshl_b32 s94, s54, 1
    s_add_u32 s94, s94, s56
    v_mfma_f32_16x16x32_bf16 v[180:183], v[72:75], v[140:143], v[180:183]
    s_and_b32 s3, s94, 3
    s_lshr_b32 s94, s94, 2
    v_mfma_f32_16x16x32_bf16 v[180:183], v[76:79], v[136:139], v[180:183]
    v_cvt_pk_bf16_f32 v36, v168, v169
    v_cvt_pk_bf16_f32 v37, v170, v171
    v_mfma_f32_16x16x32_bf16 v[180:183], v[80:83], v[132:135], v[180:183]
    v_cvt_pk_bf16_f32 v38, v172, v173
    v_cvt_pk_bf16_f32 v39, v174, v175
    v_mfma_f32_16x16x32_bf16 v[180:183], v[84:87], v[128:131], v[180:183]
    s_lshl_b32 s3, s3, 6
    s_add_u32 s94, s94, s3
    v_mfma_f32_16x16x32_bf16 v[184:187], v[64:67], v[152:155], v[184:187]
    v_permlane16_swap_b32 v36, v38
    s_add_u32 s94, s94, 56
    v_mfma_f32_16x16x32_bf16 v[184:187], v[68:71], v[148:151], v[184:187]
    v_permlane16_swap_b32 v37, v39
    s_lshl_b32 s94, s94, 10
    v_mfma_f32_16x16x32_bf16 v[184:187], v[72:75], v[144:147], v[184:187]
    s_xor_b32 s3, s2, 1
    s_andn2_b32 s3, s3, 56
    v_mfma_f32_16x16x32_bf16 v[184:187], v[76:79], v[140:143], v[184:187]
    s_add_u32 s3, s3, 0
    s_lshl_b32 s3, s3, 10
    v_mfma_f32_16x16x32_bf16 v[184:187], v[80:83], v[136:139], v[184:187]
    v_cmp_gt_u32 vcc, 32, v0
    v_mov_b32 v2, s3
    v_mfma_f32_16x16x32_bf16 v[184:187], v[84:87], v[132:135], v[184:187]
    v_mov_b32 v3, s94
    v_cndmask_b32 v2, v2, v3, vcc
    v_mfma_f32_16x16x32_bf16 v[184:187], v[88:91], v[128:131], v[184:187]
    v_and_b32 v203, 12, v20
    v_add_u32 v203, v2, v203
    v_mfma_f32_16x16x32_bf16 v[188:191], v[64:67], v[156:159], v[188:191]
    v_cvt_pk_bf16_f32 v40, v176, v177
    v_cvt_pk_bf16_f32 v41, v178, v179
    v_mfma_f32_16x16x32_bf16 v[188:191], v[68:71], v[152:155], v[188:191]
    v_cvt_pk_bf16_f32 v42, v180, v181
    v_cvt_pk_bf16_f32 v43, v182, v183
    v_mfma_f32_16x16x32_bf16 v[188:191], v[72:75], v[148:151], v[188:191]
    s_lshl_b32 s94, s54, 1
    s_add_u32 s94, s94, s56
    v_mfma_f32_16x16x32_bf16 v[188:191], v[76:79], v[144:147], v[188:191]
    v_permlane16_swap_b32 v40, v42
    s_lshl_b32 s94, s94, 10
    v_mfma_f32_16x16x32_bf16 v[188:191], v[80:83], v[140:143], v[188:191]
    v_permlane16_swap_b32 v41, v43
    s_add_u32 s94, s94, 0x2040300
    v_mfma_f32_16x16x32_bf16 v[188:191], v[84:87], v[136:139], v[188:191]
    v_add_u32 v22, s94, v20
    v_mfma_f32_16x16x32_bf16 v[188:191], v[88:91], v[132:135], v[188:191]
    v_mfma_f32_16x16x32_bf16 v[188:191], v[92:95], v[128:131], v[188:191]
    v_cvt_pk_bf16_f32 v44, v184, v185
    v_cvt_pk_bf16_f32 v45, v186, v187
    buffer_store_dwordx4 v[32:35], v201, s[20:23], s76 offen offset:0 sc1
    buffer_store_dwordx4 v[36:39], v201, s[20:23], s76 offen offset:1024 sc1
    buffer_store_dwordx4 v[40:43], v201, s[20:23], s76 offen offset:2048 sc1
    s_nop 2
    v_cvt_pk_bf16_f32 v46, v188, v189
    v_cvt_pk_bf16_f32 v47, v190, v191
    s_nop 1
    v_permlane16_swap_b32 v44, v46
    v_permlane16_swap_b32 v45, v47
    buffer_store_dwordx4 v[44:47], v201, s[20:23], s76 offen offset:3072 sc1
    s_setprio 1
    s_add_u32 s94, s63, 114688
    s_sub_u32 s52, s52, 3
    s_mov_b32 s92, 0
    s_mov_b32 s99, 0x120010
    s_bitset1_b32 s99, s52
    s_lshl_b32 s3, s7, 2
    s_add_u32 s3, s3, 163460
    v_mov_b32 v4, s3
    s_mov_b32 m0, s94
    s_waitcnt vmcnt(4)
    s_barrier
    ds_read_b32 v4, v4
    s_waitcnt lgkmcnt(0)
    v_readfirstlane_b32 s98, v4
    s_nop 1
    s_bitcmp1_b32 s98, s93
    s_cbranch_scc0 L_g2l_n3
    s_branch L_g2l_b3
L_g2l_r3:
    buffer_load_dwordx4 v212, s[16:19], s62 offen offset:0 lds
    buffer_load_dwordx4 v213, s[16:19], s62 offen offset:1024 lds
    buffer_load_dwordx4 v214, s[16:19], s62 offen offset:2048 lds
    buffer_load_dwordx4 v215, s[16:19], s62 offen offset:3072 lds
    s_bitcmp1_b32 s98, s93
    s_mov_b32 m0, s94
    s_waitcnt vmcnt(16)
    s_barrier
    s_cbranch_scc0 L_g2l_n0
L_g2l_b0:
    buffer_load_dwordx4 v1, s[20:23], s61 offen offset:0 sc1 lds
    buffer_load_dwordx4 v1, s[20:23], s61 offen offset:1024 sc1 lds
    buffer_load_dwordx4 v1, s[20:23], s61 offen offset:2048 sc1 lds
    buffer_load_dwordx4 v1, s[20:23], s61 offen offset:3072 sc1 lds
    s_add_u32 m0, s63, 0
    s_lshl_b32 s62, s93, 17
    s_add_u32 s62, s62, s58
    v_readlane_b32 s93, v23, s59
    s_add_u32 s59, s59, 1
    s_lshl_b32 s61, s93, 14
    s_add_u32 s61, s61, s57
    s_add_u32 s94, s63, 65536
    s_add_u32 s92, s92, 1
    s_bitcmp1_b32 s99, s92
    s_cbranch_scc1 L_g2l_e0
L_g2l_r0:
    buffer_load_dwordx4 v212, s[16:19], s62 offen offset:0 lds
    buffer_load_dwordx4 v213, s[16:19], s62 offen offset:1024 lds
    buffer_load_dwordx4 v214, s[16:19], s62 offen offset:2048 lds
    buffer_load_dwordx4 v215, s[16:19], s62 offen offset:3072 lds
    s_bitcmp1_b32 s98, s93
    s_mov_b32 m0, s94
    s_waitcnt vmcnt(16)
    s_barrier
    s_cbranch_scc0 L_g2l_n1
L_g2l_b1:
    buffer_load_dwordx4 v1, s[20:23], s61 offen offset:0 sc1 lds
    buffer_load_dwordx4 v1, s[20:23], s61 offen offset:1024 sc1 lds
    buffer_load_dwordx4 v1, s[20:23], s61 offen offset:2048 sc1 lds
    buffer_load_dwordx4 v1, s[20:23], s61 offen offset:3072 sc1 lds
    s_add_u32 m0, s63, 16384
    s_lshl_b32 s62, s93, 17
    s_add_u32 s62, s62, s58
    v_readlane_b32 s93, v23, s59
    s_add_u32 s59, s59, 1
    s_lshl_b32 s61, s93, 14
    s_add_u32 s61, s61, s57
    s_add_u32 s94, s63, 81920
    s_add_u32 s92, s92, 1
    s_bitcmp1_b32 s99, s92
    s_cbranch_scc1 L_g2l_e1
L_g2l_r1:
    buffer_load_dwordx4 v212, s[16:19], s62 offen offset:0 lds
    buffer_load_dwordx4 v213, s[16:19], s62 offen offset:1024 lds
    buffer_load_dwordx4 v214, s[16:19], s62 offen offset:2048 lds
    buffer_load_dwordx4 v215, s[16:19], s62 offen offset:3072 lds
    s_bitcmp1_b32 s98, s93
    s_mov_b32 m0, s94
    s_waitcnt vmcnt(16)
    s_barrier
    s_cbranch_scc0 L_g2l_n2
L_g2l_b2:
    buffer_load_dwordx4 v1, s[20:23], s61 offen offset:0 sc1 lds
    buffer_load_dwordx4 v1, s[20:23], s61 offen offset:1024 sc1 lds
    buffer_load_dwordx4 v1, s[20:23], s61 offen offset:2048 sc1 lds
    buffer_load_dwordx4 v1, s[20:23], s61 offen offset:3072 sc1 lds
    s_add_u32 m0, s63, 32768
    s_lshl_b32 s62, s93, 17
    s_add_u32 s62, s62, s58
    v_readlane_b32 s93, v23, s59
    s_add_u32 s59, s59, 1
    s_lshl_b32 s61, s93, 14
    s_add_u32 s61, s61, s57
    s_add_u32 s94, s63, 114688
    s_add_u32 s92, s92, 1
    s_bitcmp1_b32 s99, s92
    s_cbranch_scc1 L_g2l_e2
L_g2l_r2:
    buffer_load_dwordx4 v212, s[16:19], s62 offen offset:0 lds
    buffer_load_dwordx4 v213, s[16:19], s62 offen offset:1024 lds
    buffer_load_dwordx4 v214, s[16:19], s62 offen offset:2048 lds
    buffer_load_dwordx4 v215, s[16:19], s62 offen offset:3072 lds
    s_bitcmp1_b32 s98, s93
    s_mov_b32 m0, s94
    s_waitcnt vmcnt(16)
    s_barrier
    s_cbranch_scc0 L_g2l_n3
L_g2l_b3:
    buffer_load_dwordx4 v1, s[20:23], s61 offen offset:0 sc1 lds
    buffer_load_dwordx4 v1, s[20:23], s61 offen offset:1024 sc1 lds
    buffer_load_dwordx4 v1, s[20:23], s61 offen offset:2048 sc1 lds
    buffer_load_dwordx4 v1, s[20:23], s61 offen offset:3072 sc1 lds
    s_add_u32 m0, s63, 98304
    s_lshl_b32 s62, s93, 17
    s_add_u32 s62, s62, s58
    v_readlane_b32 s93, v23, s59
    s_add_u32 s59, s59, 1
    s_lshl_b32 s61, s93, 14
    s_add_u32 s61, s61, s57
    s_add_u32 s94, s63, 49152
    s_add_u32 s92, s92, 1
    s_bitcmp1_b32 s99, s92
    s_cbranch_scc1 L_g2l_e3
    s_branch L_g2l_r3
L_g2l_out:
    buffer_load_dwordx4 v212, s[16:19], s62 offen offset:0 lds
    buffer_load_dwordx4 v213, s[16:19], s62 offen offset:1024 lds
    buffer_load_dwordx4 v214, s[16:19], s62 offen offset:2048 lds
    buffer_load_dwordx4 v215, s[16:19], s62 offen offset:3072 lds
    s_lshl_b32 s62, s60, 17
    s_lshl_b32 s3, s7, 15
    s_add_u32 s62, s62, s3
    s_lshl_b32 s3, s55, 8
    s_add_u32 s62, s62, s3
    s_add_u32 m0, s63, 131072
    s_waitcnt vmcnt(16)
    s_barrier
    buffer_load_dwordx4 v204, s[8:11], s62 offen offset:0 lds
    buffer_load_dwordx4 v205, s[8:11], s62 offen offset:1024 lds
    buffer_load_dwordx4 v206, s[8:11], s62 offen offset:2048 lds
    buffer_load_dwordx4 v207, s[8:11], s62 offen offset:3072 lds
    s_add_u32 m0, s63, 147456
    s_lshl_b32 s61, s60, 7
    s_lshl_b32 s3, s55, 19
    s_add_u32 s61, s61, s3
    s_lshl_b32 s3, s7, 17
    s_add_u32 s61, s61, s3
    s_add_u32 s61, s61, 0x1400000
    buffer_load_dwordx4 v208, s[20:23], s61 offen offset:0 sc1 lds
    buffer_load_dwordx4 v209, s[20:23], s61 offen offset:1024 sc1 lds
    buffer_load_dwordx4 v210, s[20:23], s61 offen offset:2048 sc1 lds
    buffer_load_dwordx4 v211, s[20:23], s61 offen offset:3072 sc1 lds
    s_mov_b32 s94, 65536
    s_cmp_eq_u32 s56, 1
    s_cselect_b32 s94, 114688, s94
    s_add_u32 m0, s63, s94
    s_lshl_b32 s62, s60, 9
    s_add_u32 s62, s62, 0x2000000
    buffer_load_dwordx4 v1, s[20:23], s62 offen sc1 lds
    s_waitcnt vmcnt(17)
    s_barrier
    s_waitcnt vmcnt(9)
    s_barrier
    s_waitcnt vmcnt(0)
    s_barrier
    s_branch L_fin
L_cwave:
    s_cmp_eq_u32 s55, 7
    s_cbranch_scc1 L_prep
    v_mov_b32 v252, 0
    v_mov_b32 v253, 1
    s_waitcnt lgkmcnt(0)
    s_mov_b64 s[8:9], s[64:65]
    s_mov_b32 s10, 0x400000
    s_mov_b32 s11, 0x20000
    s_mov_b64 s[20:21], s[88:89]
    s_mov_b32 s22, 0x10000000
    s_mov_b32 s23, 0x20000
L_csetup:
    v_lshlrev_b32 v1, 4, v0
    v_and_b32 v16, 15, v0
    v_lshrrev_b32 v17, 4, v0
    v_lshrrev_b32 v18, 2, v16
    v_and_b32 v19, 3, v0
    v_lshrrev_b32 v20, 1, v16
    v_xor_b32 v20, v20, v17
    v_lshlrev_b32 v20, 4, v20
    v_lshl_add_u32 v20, v16, 7, v20
    v_add_u32 v2, 49152, v20
    v_xor_b32 v3, 64, v2
    v_lshl_add_u32 v20, v17, 3, v18
    v_lshlrev_b32 v20, 9, v20
    v_lshl_add_u32 v20, v19, 3, v20
    v_and_b32 v21, 1, v17
    v_lshl_or_b32 v21, v21, 2, v18
    s_lshr_b32 s77, s7, 1
    s_and_b32 s0, s7, 1
    s_lshl_b32 s57, s77, 8
    s_add_u32 s57, s57, 65536
    v_add_u32 v20, s57, v20
    s_lshl_b32 s58, s0, 2
    v_xor_b32 v21, s58, v21
    v_xor_b32 v23, 0, v21
    v_lshl_add_u32 v4, v23, 5, v20
    v_xor_b32 v23, 1, v21
    v_lshl_add_u32 v5, v23, 5, v20
    v_xor_b32 v23, 2, v21
    v_lshl_add_u32 v6, v23, 5, v20
    v_xor_b32 v23, 3, v21
    v_lshl_add_u32 v7, v23, 5, v20
    v_lshrrev_b32 v22, 2, v0
    v_lshlrev_b32 v22, 8, v22
    v_lshl_add_u32 v22, v19, 3, v22
    v_xor_b32 v23, 0, v21
    v_lshl_add_u32 v10, v23, 5, v22
    v_xor_b32 v23, 1, v21
    v_lshl_add_u32 v11, v23, 5, v22
    v_xor_b32 v23, 2, v21
    v_lshl_add_u32 v12, v23, 5, v22
    v_xor_b32 v23, 3, v21
    v_lshl_add_u32 v13, v23, 5, v22
    s_lshl_b32 s59, s56, 12
    s_lshl_b32 s3, s77, 11
    s_add_u32 s59, s59, s3
    s_add_u32 s59, s59, 49152
    v_add_u32 v8, s59, v1
    v_xor_b32 v9, 4096, v8
    v_add_u32 v112, 65536, v8
    v_add_u32 v113, 65536, v9
    v_add_u32 v114, 98304, v10
    v_add_u32 v115, 98304, v11
    v_add_u32 v116, 98304, v12
    v_add_u32 v117, 98304, v13
    v_lshrrev_b32 v22, 4, v0
    v_and_b32 v20, 15, v0
    v_lshlrev_b32 v21, 1, v22
    v_xor_b32 v20, v20, v21
    v_lshlrev_b32 v20, 4, v20
    v_lshl_add_u32 v20, v22, 11, v20
    v_xor_b32 v21, 128, v20
    v_add_u32 v248, 0, v20
    v_add_u32 v249, 7168, v21
    v_add_u32 v250, 14336, v20
    v_add_u32 v251, 21504, v21
    s_lshl_b32 s90, s54, 1
    s_add_u32 s90, s90, s56
    s_lshl_b32 s90, s90, 10
    s_add_u32 s90, s90, 0x2040300
    s_lshl2_add_u32 s3, s95, s7
    s_lshl2_add_u32 s1, s3, s90
    v_min_u32 v22, 27, v0
    v_lshl_add_u32 v14, v22, 2, s90
    s_andn2_b32 s3, 1, s55
    s_mul_i32 s3, s3, 3
    s_add_u32 s3, s3, 0
    v_add_u32 v20, s3, v0
    v_subrev_u32 v21, 28, v20
    v_min_u32 v20, v20, v21
    s_lshr_b32 s3, s55, 1
    s_add_u32 s3, s54, s3
    v_add_u32 v21, s3, v20
    v_and_b32 v21, 3, v21
    v_and_b32 v20, 28, v20
    s_lshr_b32 s3, s54, 2
    s_mul_i32 s3, s3, 8
    v_add3_u32 v20, v20, v21, s3
    v_cmp_gt_u32 vcc, 28, v0
    v_subrev_u32 v21, 28, v20
    v_min_u32 v20, v20, v21
    v_cndmask_b32 v118, v0, v20, vcc
    s_mul_i32 s3, s56, 1
    s_lshl_b32 s52, s3, 1
    s_sub_u32 s52, 29, s52
    v_cmp_le_u32 vcc, s3, v118
    v_mov_b32 v21, 63
    s_nop 0
    v_mbcnt_lo_u32_b32 v20, vcc_lo, 0
    v_mbcnt_hi_u32_b32 v20, vcc_hi, v20
    v_cndmask_b32 v20, v21, v20, vcc
    v_lshlrev_b32 v20, 2, v20
    ds_permute_b32 v118, v20, v118
    s_waitcnt lgkmcnt(0)
    s_mul_i32 s60, s54, 917504
    s_lshl_b32 s3, s53, 16
    s_add_u32 s60, s60, s3
    s_lshl_b32 s3, s7, 14
    s_add_u32 s60, s60, s3
    s_add_u32 s61, s60, 0x1000
    s_add_u32 s62, s60, 0x2000
    s_add_u32 s63, s60, 0x3000
    s_cmp_eq_u32 s55, 7
    s_cbranch_scc1 L_help_c
    s_mov_b32 s92, 0
    s_mov_b32 s57, 1
    s_mov_b32 s59, 0xc000
    v_mov_b32 v15, 163456
    s_waitcnt vmcnt(0)
    s_lshr_b32 s3, s54, 2
    s_lshl_b32 s3, s3, 1
    s_sub_u32 s3, s95, s3
    s_cselect_b32 s93, 7, 0
    s_add_u32 s3, s3, s93
    s_lshr_b32 s93, 98, s3
    s_and_b32 s93, s93, 1
    s_cmp_eq_u32 s53, 7
    s_cselect_b32 s93, 0, s93
    s_barrier
    ds_read_b64_tr_b16 v[48:49], v4 offset:0
    ds_read_b64_tr_b16 v[50:51], v4 offset:2048
    ds_read_b64_tr_b16 v[52:53], v4 offset:16384
    ds_read_b64_tr_b16 v[54:55], v4 offset:18432
    ds_read_b128 v[16:19], v2 offset:0
    ds_read_b128 v[20:23], v3 offset:0
    ds_read_b64_tr_b16 v[56:57], v5 offset:0
    ds_read_b64_tr_b16 v[58:59], v5 offset:2048
    ds_read_b64_tr_b16 v[60:61], v5 offset:16384
    ds_read_b64_tr_b16 v[62:63], v5 offset:18432
    ds_read_b64_tr_b16 v[64:65], v6 offset:0
    ds_read_b64_tr_b16 v[66:67], v6 offset:2048
    ds_read_b64_tr_b16 v[68:69], v6 offset:16384
    ds_read_b64_tr_b16 v[70:71], v6 offset:18432
    ds_read_b64_tr_b16 v[72:73], v7 offset:0
    ds_read_b64_tr_b16 v[74:75], v7 offset:2048
    ds_read_b64_tr_b16 v[76:77], v7 offset:16384
    ds_read_b64_tr_b16 v[78:79], v7 offset:18432
    ds_read_b128 v[24:27], v2 offset:2048
    ds_read_b128 v[28:31], v3 offset:2048
    ds_read_b128 v[32:35], v2 offset:4096
    ds_read_b128 v[36:39], v3 offset:4096
    s_waitcnt lgkmcnt(6)
    v_mfma_f32_16x16x32_bf16 v[120:123], v[48:51], v[16:19], 0
    ds_read_b128 v[40:43], v2 offset:6144
    v_mfma_f32_16x16x32_bf16 v[120:123], v[52:55], v[20:23], v[120:123]
    ds_read_b128 v[44:47], v3 offset:6144
    v_mfma_f32_16x16x32_bf16 v[124:127], v[60:63], v[20:23], 0
    v_mfma_f32_16x16x32_bf16 v[124:127], v[56:59], v[16:19], v[124:127]
    v_mfma_f32_16x16x32_bf16 v[184:187], v[64:67], v[16:19], 0
    v_mfma_f32_16x16x32_bf16 v[184:187], v[68:71], v[20:23], v[184:187]
    s_waitcnt lgkmcnt(4)
    v_mfma_f32_16x16x32_bf16 v[188:191], v[76:79], v[20:23], 0
    v_mfma_f32_16x16x32_bf16 v[188:191], v[72:75], v[16:19], v[188:191]
    v_mfma_f32_16x16x32_bf16 v[196:199], v[72:75], v[24:27], 0
    ds_read_b128 v[16:19], v2 offset:8192
    v_mfma_f32_16x16x32_bf16 v[196:199], v[76:79], v[28:31], v[196:199]
    ds_read_b128 v[20:23], v3 offset:8192
    v_mfma_f32_16x16x32_bf16 v[192:195], v[68:71], v[28:31], 0
    s_add_u32 s57, s57, 1
    v_mfma_f32_16x16x32_bf16 v[192:195], v[64:67], v[24:27], v[192:195]
    s_cmp_eq_u32 s57, 3
    v_mfma_f32_16x16x32_bf16 v[132:135], v[56:59], v[24:27], 0
    s_cselect_b32 s57, 0, s57
    v_mfma_f32_16x16x32_bf16 v[132:135], v[60:63], v[28:31], v[132:135]
    s_cselect_b32 s58, 0xfffe8000, s59
    v_mfma_f32_16x16x32_bf16 v[128:131], v[52:55], v[28:31], 0
    v_mfma_f32_16x16x32_bf16 v[128:131], v[48:51], v[24:27], v[128:131]
    s_waitcnt lgkmcnt(4)
    v_mfma_f32_16x16x32_bf16 v[136:139], v[48:51], v[32:35], 0
    ds_read_b128 v[24:27], v2 offset:10240
    v_mfma_f32_16x16x32_bf16 v[136:139], v[52:55], v[36:39], v[136:139]
    ds_read_b128 v[28:31], v3 offset:10240
    v_mfma_f32_16x16x32_bf16 v[140:143], v[60:63], v[36:39], 0
    v_mfma_f32_16x16x32_bf16 v[140:143], v[56:59], v[32:35], v[140:143]
    v_mfma_f32_16x16x32_bf16 v[200:203], v[64:67], v[32:35], 0
    v_mfma_f32_16x16x32_bf16 v[200:203], v[68:71], v[36:39], v[200:203]
    v_mfma_f32_16x16x32_bf16 v[204:207], v[76:79], v[36:39], 0
    v_mfma_f32_16x16x32_bf16 v[204:207], v[72:75], v[32:35], v[204:207]
    s_waitcnt lgkmcnt(4)
    v_mfma_f32_16x16x32_bf16 v[212:215], v[72:75], v[40:43], 0
    ds_read_b128 v[32:35], v2 offset:12288
    v_mfma_f32_16x16x32_bf16 v[212:215], v[76:79], v[44:47], v[212:215]
    ds_read_b128 v[36:39], v3 offset:12288
    v_mfma_f32_16x16x32_bf16 v[208:211], v[68:71], v[44:47], 0
    v_mfma_f32_16x16x32_bf16 v[208:211], v[64:67], v[40:43], v[208:211]
    v_mfma_f32_16x16x32_bf16 v[148:151], v[56:59], v[40:43], 0
    v_mfma_f32_16x16x32_bf16 v[148:151], v[60:63], v[44:47], v[148:151]
    v_mfma_f32_16x16x32_bf16 v[144:147], v[52:55], v[44:47], 0
    v_mfma_f32_16x16x32_bf16 v[144:147], v[48:51], v[40:43], v[144:147]
    s_waitcnt lgkmcnt(4)
    v_mfma_f32_16x16x32_bf16 v[152:155], v[48:51], v[16:19], 0
    ds_read_b128 v[40:43], v2 offset:14336
    v_mfma_f32_16x16x32_bf16 v[152:155], v[52:55], v[20:23], v[152:155]
    ds_read_b128 v[44:47], v3 offset:14336
    v_mfma_f32_16x16x32_bf16 v[156:159], v[60:63], v[20:23], 0
    v_add_u32 v4, s58, v4
    v_add_u32 v2, s58, v2
    v_mfma_f32_16x16x32_bf16 v[156:159], v[56:59], v[16:19], v[156:159]
    v_add_u32 v5, s58, v5
    v_add_u32 v6, s58, v6
    v_mfma_f32_16x16x32_bf16 v[216:219], v[64:67], v[16:19], 0
    v_add_u32 v7, s58, v7
    v_add_u32 v3, s58, v3
    v_mfma_f32_16x16x32_bf16 v[216:219], v[68:71], v[20:23], v[216:219]
    v_mfma_f32_16x16x32_bf16 v[220:223], v[76:79], v[20:23], 0
    v_mfma_f32_16x16x32_bf16 v[220:223], v[72:75], v[16:19], v[220:223]
    s_waitcnt lgkmcnt(4)
    v_mfma_f32_16x16x32_bf16 v[228:231], v[72:75], v[24:27], 0
    s_waitcnt lgkmcnt(0)
    s_barrier
    v_mfma_f32_16x16x32_bf16 v[228:231], v[76:79], v[28:31], v[228:231]
    ds_read_b64_tr_b16 v[80:81], v4 offset:0
    v_mfma_f32_16x16x32_bf16 v[224:227], v[68:71], v[28:31], 0
    ds_read_b64_tr_b16 v[82:83], v4 offset:2048
    v_mfma_f32_16x16x32_bf16 v[224:227], v[64:67], v[24:27], v[224:227]
    ds_read_b128 v[16:19], v2 offset:0
    v_mfma_f32_16x16x32_bf16 v[164:167], v[56:59], v[24:27], 0
    ds_read_b64_tr_b16 v[84:85], v4 offset:16384
    v_mfma_f32_16x16x32_bf16 v[164:167], v[60:63], v[28:31], v[164:167]
    ds_read_b64_tr_b16 v[86:87], v4 offset:18432
    v_mfma_f32_16x16x32_bf16 v[160:163], v[52:55], v[28:31], 0
    ds_read_b128 v[20:23], v3 offset:0
    v_mfma_f32_16x16x32_bf16 v[160:163], v[48:51], v[24:27], v[160:163]
    ds_read_b64_tr_b16 v[88:89], v5 offset:0
    v_mfma_f32_16x16x32_bf16 v[168:171], v[48:51], v[32:35], 0
    ds_read_b64_tr_b16 v[90:91], v5 offset:2048
    v_mfma_f32_16x16x32_bf16 v[168:171], v[52:55], v[36:39], v[168:171]
    ds_read_b64_tr_b16 v[92:93], v5 offset:16384
    v_mfma_f32_16x16x32_bf16 v[172:175], v[60:63], v[36:39], 0
    ds_read_b64_tr_b16 v[94:95], v5 offset:18432
    v_mfma_f32_16x16x32_bf16 v[172:175], v[56:59], v[32:35], v[172:175]
    ds_read_b128 v[24:27], v2 offset:2048
    v_mfma_f32_16x16x32_bf16 v[232:235], v[64:67], v[32:35], 0
    ds_read_b64_tr_b16 v[96:97], v6 offset:0
    v_mfma_f32_16x16x32_bf16 v[232:235], v[68:71], v[36:39], v[232:235]
    ds_read_b64_tr_b16 v[98:99], v6 offset:2048
    v_mfma_f32_16x16x32_bf16 v[236:239], v[76:79], v[36:39], 0
    ds_read_b128 v[28:31], v3 offset:2048
    v_mfma_f32_16x16x32_bf16 v[236:239], v[72:75], v[32:35], v[236:239]
    ds_read_b64_tr_b16 v[100:101], v6 offset:16384
    v_mfma_f32_16x16x32_bf16 v[244:247], v[72:75], v[40:43], 0
    ds_read_b64_tr_b16 v[102:103], v6 offset:18432
    v_mfma_f32_16x16x32_bf16 v[244:247], v[76:79], v[44:47], v[244:247]
    ds_read_b64_tr_b16 v[104:105], v7 offset:0
    v_mfma_f32_16x16x32_bf16 v[240:243], v[68:71], v[44:47], 0
    ds_read_b64_tr_b16 v[106:107], v7 offset:2048
    v_mfma_f32_16x16x32_bf16 v[240:243], v[64:67], v[40:43], v[240:243]
    ds_read_b64_tr_b16 v[108:109], v7 offset:16384
    v_mfma_f32_16x16x32_bf16 v[180:183], v[56:59], v[40:43], 0
    ds_read_b64_tr_b16 v[110:111], v7 offset:18432
    v_mfma_f32_16x16x32_bf16 v[180:183], v[60:63], v[44:47], v[180:183]
    ds_read_b128 v[32:35], v2 offset:4096
    v_mfma_f32_16x16x32_bf16 v[176:179], v[52:55], v[44:47], 0
    ds_read_b128 v[36:39], v3 offset:4096
    v_mfma_f32_16x16x32_bf16 v[176:179], v[48:51], v[40:43], v[176:179]
    .p2align 6
L_g1c_loop:
    s_waitcnt lgkmcnt(6)
    v_mfma_f32_16x16x32_bf16 v[120:123], v[80:83], v[16:19], v[120:123]
    ds_read_b128 v[40:43], v2 offset:6144
    v_mfma_f32_16x16x32_bf16 v[120:123], v[84:87], v[20:23], v[120:123]
    ds_read_b128 v[44:47], v3 offset:6144
    v_mfma_f32_16x16x32_bf16 v[124:127], v[92:95], v[20:23], v[124:127]
    v_mfma_f32_16x16x32_bf16 v[124:127], v[88:91], v[16:19], v[124:127]
    v_mfma_f32_16x16x32_bf16 v[184:187], v[96:99], v[16:19], v[184:187]
    v_mfma_f32_16x16x32_bf16 v[184:187], v[100:103], v[20:23], v[184:187]
    s_waitcnt lgkmcnt(4)
    v_mfma_f32_16x16x32_bf16 v[188:191], v[108:111], v[20:23], v[188:191]
    v_mfma_f32_16x16x32_bf16 v[188:191], v[104:107], v[16:19], v[188:191]
    v_mfma_f32_16x16x32_bf16 v[196:199], v[104:107], v[24:27], v[196:199]
    ds_read_b128 v[16:19], v2 offset:8192
    v_mfma_f32_16x16x32_bf16 v[196:199], v[108:111], v[28:31], v[196:199]
    ds_read_b128 v[20:23], v3 offset:8192
    v_mfma_f32_16x16x32_bf16 v[192:195], v[100:103], v[28:31], v[192:195]
    s_add_u32 s57, s57, 1
    v_mfma_f32_16x16x32_bf16 v[192:195], v[96:99], v[24:27], v[192:195]
    s_cmp_eq_u32 s57, 3
    v_mfma_f32_16x16x32_bf16 v[132:135], v[88:91], v[24:27], v[132:135]
    s_cselect_b32 s57, 0, s57
    v_mfma_f32_16x16x32_bf16 v[132:135], v[92:95], v[28:31], v[132:135]
    s_cselect_b32 s58, 0xfffe8000, s59
    v_mfma_f32_16x16x32_bf16 v[128:131], v[84:87], v[28:31], v[128:131]
    v_mfma_f32_16x16x32_bf16 v[128:131], v[80:83], v[24:27], v[128:131]
    s_waitcnt lgkmcnt(4)
    v_mfma_f32_16x16x32_bf16 v[136:139], v[80:83], v[32:35], v[136:139]
    ds_read_b128 v[24:27], v2 offset:10240
    v_mfma_f32_16x16x32_bf16 v[136:139], v[84:87], v[36:39], v[136:139]
    ds_read_b128 v[28:31], v3 offset:10240
    v_mfma_f32_16x16x32_bf16 v[140:143], v[92:95], v[36:39], v[140:143]
    v_mfma_f32_16x16x32_bf16 v[140:143], v[88:91], v[32:35], v[140:143]
    v_mfma_f32_16x16x32_bf16 v[200:203], v[96:99], v[32:35], v[200:203]
    v_mfma_f32_16x16x32_bf16 v[200:203], v[100:103], v[36:39], v[200:203]
    v_mfma_f32_16x16x32_bf16 v[204:207], v[108:111], v[36:39], v[204:207]
    v_mfma_f32_16x16x32_bf16 v[204:207], v[104:107], v[32:35], v[204:207]
    s_waitcnt lgkmcnt(4)
    v_mfma_f32_16x16x32_bf16 v[212:215], v[104:107], v[40:43], v[212:215]
    ds_read_b128 v[32:35], v2 offset:12288
    v_mfma_f32_16x16x32_bf16 v[212:215], v[108:111], v[44:47], v[212:215]
    ds_read_b128 v[36:39], v3 offset:12288
    v_mfma_f32_16x16x32_bf16 v[208:211], v[100:103], v[44:47], v[208:211]
    v_mfma_f32_16x16x32_bf16 v[208:211], v[96:99], v[40:43], v[208:211]
    v_mfma_f32_16x16x32_bf16 v[148:151], v[88:91], v[40:43], v[148:151]
    v_mfma_f32_16x16x32_bf16 v[148:151], v[92:95], v[44:47], v[148:151]
    v_mfma_f32_16x16x32_bf16 v[144:147], v[84:87], v[44:47], v[144:147]
    v_mfma_f32_16x16x32_bf16 v[144:147], v[80:83], v[40:43], v[144:147]
    s_waitcnt lgkmcnt(4)
    v_mfma_f32_16x16x32_bf16 v[152:155], v[80:83], v[16:19], v[152:155]
    ds_read_b128 v[40:43], v2 offset:14336
    v_mfma_f32_16x16x32_bf16 v[152:155], v[84:87], v[20:23], v[152:155]
    ds_read_b128 v[44:47], v3 offset:14336
    v_mfma_f32_16x16x32_bf16 v[156:159], v[92:95], v[20:23], v[156:159]
    v_add_u32 v4, s58, v4
    v_add_u32 v2, s58, v2
    v_mfma_f32_16x16x32_bf16 v[156:159], v[88:91], v[16:19], v[156:159]
    v_add_u32 v5, s58, v5
    v_add_u32 v6, s58, v6
    v_mfma_f32_16x16x32_bf16 v[216:219], v[96:99], v[16:19], v[216:219]
    v_add_u32 v7, s58, v7
    v_add_u32 v3, s58, v3
    v_mfma_f32_16x16x32_bf16 v[216:219], v[100:103], v[20:23], v[216:219]
    v_mfma_f32_16x16x32_bf16 v[220:223], v[108:111], v[20:23], v[220:223]
    v_mfma_f32_16x16x32_bf16 v[220:223], v[104:107], v[16:19], v[220:223]
    s_waitcnt lgkmcnt(4)
    v_mfma_f32_16x16x32_bf16 v[228:231], v[104:107], v[24:27], v[228:231]
    s_waitcnt lgkmcnt(0)
    s_barrier
    v_mfma_f32_16x16x32_bf16 v[228:231], v[108:111], v[28:31], v[228:231]
    ds_read_b64_tr_b16 v[48:49], v4 offset:0
    v_mfma_f32_16x16x32_bf16 v[224:227], v[100:103], v[28:31], v[224:227]
    ds_read_b64_tr_b16 v[50:51], v4 offset:2048
    v_mfma_f32_16x16x32_bf16 v[224:227], v[96:99], v[24:27], v[224:227]
    ds_read_b128 v[16:19], v2 offset:0
    v_mfma_f32_16x16x32_bf16 v[164:167], v[88:91], v[24:27], v[164:167]
    ds_read_b64_tr_b16 v[52:53], v4 offset:16384
    v_mfma_f32_16x16x32_bf16 v[164:167], v[92:95], v[28:31], v[164:167]
    ds_read_b64_tr_b16 v[54:55], v4 offset:18432
    v_mfma_f32_16x16x32_bf16 v[160:163], v[84:87], v[28:31], v[160:163]
    ds_read_b128 v[20:23], v3 offset:0
    v_mfma_f32_16x16x32_bf16 v[160:163], v[80:83], v[24:27], v[160:163]
    ds_read_b64_tr_b16 v[56:57], v5 offset:0
    v_mfma_f32_16x16x32_bf16 v[168:171], v[80:83], v[32:35], v[168:171]
    ds_read_b64_tr_b16 v[58:59], v5 offset:2048
    v_mfma_f32_16x16x32_bf16 v[168:171], v[84:87], v[36:39], v[168:171]
    ds_read_b64_tr_b16 v[60:61], v5 offset:16384
    v_mfma_f32_16x16x32_bf16 v[172:175], v[92:95], v[36:39], v[172:175]
    ds_read_b64_tr_b16 v[62:63], v5 offset:18432
    v_mfma_f32_16x16x32_bf16 v[172:175], v[88:91], v[32:35], v[172:175]
    ds_read_b128 v[24:27], v2 offset:2048
    v_mfma_f32_16x16x32_bf16 v[232:235], v[96:99], v[32:35], v[232:235]
    ds_read_b64_tr_b16 v[64:65], v6 offset:0
    v_mfma_f32_16x16x32_bf16 v[232:235], v[100:103], v[36:39], v[232:235]
    ds_read_b64_tr_b16 v[66:67], v6 offset:2048
    v_mfma_f32_16x16x32_bf16 v[236:239], v[108:111], v[36:39], v[236:239]
    ds_read_b128 v[28:31], v3 offset:2048
    v_mfma_f32_16x16x32_bf16 v[236:239], v[104:107], v[32:35], v[236:239]
    ds_read_b64_tr_b16 v[68:69], v6 offset:16384
    v_mfma_f32_16x16x32_bf16 v[244:247], v[104:107], v[40:43], v[244:247]
    ds_read_b64_tr_b16 v[70:71], v6 offset:18432
    v_mfma_f32_16x16x32_bf16 v[244:247], v[108:111], v[44:47], v[244:247]
    ds_read_b64_tr_b16 v[72:73], v7 offset:0
    v_mfma_f32_16x16x32_bf16 v[240:243], v[100:103], v[44:47], v[240:243]
    ds_read_b64_tr_b16 v[74:75], v7 offset:2048
    v_mfma_f32_16x16x32_bf16 v[240:243], v[96:99], v[40:43], v[240:243]
    ds_read_b64_tr_b16 v[76:77], v7 offset:16384
    v_mfma_f32_16x16x32_bf16 v[180:183], v[88:91], v[40:43], v[180:183]
    ds_read_b64_tr_b16 v[78:79], v7 offset:18432
    v_mfma_f32_16x16x32_bf16 v[180:183], v[92:95], v[44:47], v[180:183]
    ds_read_b128 v[32:35], v2 offset:4096
    v_mfma_f32_16x16x32_bf16 v[176:179], v[84:87], v[44:47], v[176:179]
    ds_read_b128 v[36:39], v3 offset:4096
    v_mfma_f32_16x16x32_bf16 v[176:179], v[80:83], v[40:43], v[176:179]
    s_waitcnt lgkmcnt(6)
    v_mfma_f32_16x16x32_bf16 v[120:123], v[48:51], v[16:19], v[120:123]
    ds_read_b128 v[40:43], v2 offset:6144
    v_mfma_f32_16x16x32_bf16 v[120:123], v[52:55], v[20:23], v[120:123]
    ds_read_b128 v[44:47], v3 offset:6144
    v_mfma_f32_16x16x32_bf16 v[124:127], v[60:63], v[20:23], v[124:127]
    v_mfma_f32_16x16x32_bf16 v[124:127], v[56:59], v[16:19], v[124:127]
    v_mfma_f32_16x16x32_bf16 v[184:187], v[64:67], v[16:19], v[184:187]
    v_mfma_f32_16x16x32_bf16 v[184:187], v[68:71], v[20:23], v[184:187]
    s_waitcnt lgkmcnt(4)
    v_mfma_f32_16x16x32_bf16 v[188:191], v[76:79], v[20:23], v[188:191]
    v_mfma_f32_16x16x32_bf16 v[188:191], v[72:75], v[16:19], v[188:191]
    v_mfma_f32_16x16x32_bf16 v[196:199], v[72:75], v[24:27], v[196:199]
    ds_read_b128 v[16:19], v2 offset:8192
    v_mfma_f32_16x16x32_bf16 v[196:199], v[76:79], v[28:31], v[196:199]
    ds_read_b128 v[20:23], v3 offset:8192
    v_mfma_f32_16x16x32_bf16 v[192:195], v[68:71], v[28:31], v[192:195]
    s_add_u32 s57, s57, 1
    v_mfma_f32_16x16x32_bf16 v[192:195], v[64:67], v[24:27], v[192:195]
    s_cmp_eq_u32 s57, 3
    v_mfma_f32_16x16x32_bf16 v[132:135], v[56:59], v[24:27], v[132:135]
    s_cselect_b32 s57, 0, s57
    v_mfma_f32_16x16x32_bf16 v[132:135], v[60:63], v[28:31], v[132:135]
    s_cselect_b32 s58, 0xfffe8000, s59
    v_mfma_f32_16x16x32_bf16 v[128:131], v[52:55], v[28:31], v[128:131]
    v_mfma_f32_16x16x32_bf16 v[128:131], v[48:51], v[24:27], v[128:131]
    s_waitcnt lgkmcnt(4)
    v_mfma_f32_16x16x32_bf16 v[136:139], v[48:51], v[32:35], v[136:139]
    ds_read_b128 v[24:27], v2 offset:10240
    v_mfma_f32_16x16x32_bf16 v[136:139], v[52:55], v[36:39], v[136:139]
    ds_read_b128 v[28:31], v3 offset:10240
    v_mfma_f32_16x16x32_bf16 v[140:143], v[60:63], v[36:39], v[140:143]
    s_add_u32 s92, s92, 1
    v_mfma_f32_16x16x32_bf16 v[140:143], v[56:59], v[32:35], v[140:143]
    s_cmp_lt_u32 s92, 7
    v_mfma_f32_16x16x32_bf16 v[200:203], v[64:67], v[32:35], v[200:203]
    v_mfma_f32_16x16x32_bf16 v[200:203], v[68:71], v[36:39], v[200:203]
    v_mfma_f32_16x16x32_bf16 v[204:207], v[76:79], v[36:39], v[204:207]
    v_mfma_f32_16x16x32_bf16 v[204:207], v[72:75], v[32:35], v[204:207]
    s_waitcnt lgkmcnt(4)
    v_mfma_f32_16x16x32_bf16 v[212:215], v[72:75], v[40:43], v[212:215]
    ds_read_b128 v[32:35], v2 offset:12288
    v_mfma_f32_16x16x32_bf16 v[212:215], v[76:79], v[44:47], v[212:215]
    ds_read_b128 v[36:39], v3 offset:12288
    v_mfma_f32_16x16x32_bf16 v[208:211], v[68:71], v[44:47], v[208:211]
    v_mfma_f32_16x16x32_bf16 v[208:211], v[64:67], v[40:43], v[208:211]
    v_mfma_f32_16x16x32_bf16 v[148:151], v[56:59], v[40:43], v[148:151]
    v_mfma_f32_16x16x32_bf16 v[148:151], v[60:63], v[44:47], v[148:151]
    v_mfma_f32_16x16x32_bf16 v[144:147], v[52:55], v[44:47], v[144:147]
    v_mfma_f32_16x16x32_bf16 v[144:147], v[48:51], v[40:43], v[144:147]
    s_waitcnt lgkmcnt(4)
    v_mfma_f32_16x16x32_bf16 v[152:155], v[48:51], v[16:19], v[152:155]
    ds_read_b128 v[40:43], v2 offset:14336
    v_mfma_f32_16x16x32_bf16 v[152:155], v[52:55], v[20:23], v[152:155]
    ds_read_b128 v[44:47], v3 offset:14336
    v_mfma_f32_16x16x32_bf16 v[156:159], v[60:63], v[20:23], v[156:159]
    v_add_u32 v4, s58, v4
    v_add_u32 v2, s58, v2
    v_mfma_f32_16x16x32_bf16 v[156:159], v[56:59], v[16:19], v[156:159]
    v_add_u32 v5, s58, v5
    v_add_u32 v6, s58, v6
    v_mfma_f32_16x16x32_bf16 v[216:219], v[64:67], v[16:19], v[216:219]
    v_add_u32 v7, s58, v7
    v_add_u32 v3, s58, v3
    v_mfma_f32_16x16x32_bf16 v[216:219], v[68:71], v[20:23], v[216:219]
    ds_read_b32 v119, v15
    v_mfma_f32_16x16x32_bf16 v[220:223], v[76:79], v[20:23], v[220:223]
    v_mfma_f32_16x16x32_bf16 v[220:223], v[72:75], v[16:19], v[220:223]
    s_waitcnt lgkmcnt(5)
    v_mfma_f32_16x16x32_bf16 v[228:231], v[72:75], v[24:27], v[228:231]
    s_waitcnt lgkmcnt(0)
    s_barrier
    v_mfma_f32_16x16x32_bf16 v[228:231], v[76:79], v[28:31], v[228:231]
    ds_read_b64_tr_b16 v[80:81], v4 offset:0
    v_mfma_f32_16x16x32_bf16 v[224:227], v[68:71], v[28:31], v[224:227]
    ds_read_b64_tr_b16 v[82:83], v4 offset:2048
    v_mfma_f32_16x16x32_bf16 v[224:227], v[64:67], v[24:27], v[224:227]
    ds_read_b128 v[16:19], v2 offset:0
    v_mfma_f32_16x16x32_bf16 v[164:167], v[56:59], v[24:27], v[164:167]
    ds_read_b64_tr_b16 v[84:85], v4 offset:16384
    v_mfma_f32_16x16x32_bf16 v[164:167], v[60:63], v[28:31], v[164:167]
    ds_read_b64_tr_b16 v[86:87], v4 offset:18432
    v_mfma_f32_16x16x32_bf16 v[160:163], v[52:55], v[28:31], v[160:163]
    ds_read_b128 v[20:23], v3 offset:0
    v_mfma_f32_16x16x32_bf16 v[160:163], v[48:51], v[24:27], v[160:163]
    ds_read_b64_tr_b16 v[88:89], v5 offset:0
    v_mfma_f32_16x16x32_bf16 v[168:171], v[48:51], v[32:35], v[168:171]
    ds_read_b64_tr_b16 v[90:91], v5 offset:2048
    v_mfma_f32_16x16x32_bf16 v[168:171], v[52:55], v[36:39], v[168:171]
    ds_read_b64_tr_b16 v[92:93], v5 offset:16384
    v_mfma_f32_16x16x32_bf16 v[172:175], v[60:63], v[36:39], v[172:175]
    ds_read_b64_tr_b16 v[94:95], v5 offset:18432
    v_mfma_f32_16x16x32_bf16 v[172:175], v[56:59], v[32:35], v[172:175]
    ds_read_b128 v[24:27], v2 offset:2048
    v_mfma_f32_16x16x32_bf16 v[232:235], v[64:67], v[32:35], v[232:235]
    ds_read_b64_tr_b16 v[96:97], v6 offset:0
    v_mfma_f32_16x16x32_bf16 v[232:235], v[68:71], v[36:39], v[232:235]
    ds_read_b64_tr_b16 v[98:99], v6 offset:2048
    v_mfma_f32_16x16x32_bf16 v[236:239], v[76:79], v[36:39], v[236:239]
    ds_read_b128 v[28:31], v3 offset:2048
    v_mfma_f32_16x16x32_bf16 v[236:239], v[72:75], v[32:35], v[236:239]
    ds_read_b64_tr_b16 v[100:101], v6 offset:16384
    v_mfma_f32_16x16x32_bf16 v[244:247], v[72:75], v[40:43], v[244:247]
    ds_read_b64_tr_b16 v[102:103], v6 offset:18432
    v_mfma_f32_16x16x32_bf16 v[244:247], v[76:79], v[44:47], v[244:247]
    ds_read_b64_tr_b16 v[104:105], v7 offset:0
    v_mfma_f32_16x16x32_bf16 v[240:243], v[68:71], v[44:47], v[240:243]
    ds_read_b64_tr_b16 v[106:107], v7 offset:2048
    v_mfma_f32_16x16x32_bf16 v[240:243], v[64:67], v[40:43], v[240:243]
    ds_read_b64_tr_b16 v[108:109], v7 offset:16384
    v_mfma_f32_16x16x32_bf16 v[180:183], v[56:59], v[40:43], v[180:183]
    ds_read_b64_tr_b16 v[110:111], v7 offset:18432
    v_mfma_f32_16x16x32_bf16 v[180:183], v[60:63], v[44:47], v[180:183]
    ds_read_b128 v[32:35], v2 offset:4096
    v_mfma_f32_16x16x32_bf16 v[176:179], v[52:55], v[44:47], v[176:179]
    ds_read_b128 v[36:39], v3 offset:4096
    v_mfma_f32_16x16x32_bf16 v[176:179], v[48:51], v[40:43], v[176:179]
    v_readfirstlane_b32 s74, v119
    s_cbranch_scc1 L_g1c_loop
    s_and_b32 s3, s74, s93
    s_cbranch_scc1 L_g1c_plain
    s_waitcnt lgkmcnt(6)
    v_mfma_f32_16x16x32_bf16 v[120:123], v[80:83], v[16:19], v[120:123]
    ds_read_b128 v[40:43], v2 offset:6144
    v_mfma_f32_16x16x32_bf16 v[120:123], v[84:87], v[20:23], v[120:123]
    ds_read_b128 v[44:47], v3 offset:6144
    v_mfma_f32_16x16x32_bf16 v[124:127], v[92:95], v[20:23], v[124:127]
    v_mfma_f32_16x16x32_bf16 v[124:127], v[88:91], v[16:19], v[124:127]
    v_mfma_f32_16x16x32_bf16 v[184:187], v[96:99], v[16:19], v[184:187]
    v_mfma_f32_16x16x32_bf16 v[184:187], v[100:103], v[20:23], v[184:187]
    s_waitcnt lgkmcnt(4)
    v_mfma_f32_16x16x32_bf16 v[188:191], v[108:111], v[20:23], v[188:191]
    v_mfma_f32_16x16x32_bf16 v[188:191], v[104:107], v[16:19], v[188:191]
    v_mfma_f32_16x16x32_bf16 v[196:199], v[104:107], v[24:27], v[196:199]
    ds_read_b128 v[16:19], v2 offset:8192
    v_mfma_f32_16x16x32_bf16 v[196:199], v[108:111], v[28:31], v[196:199]
    ds_read_b128 v[20:23], v3 offset:8192
    v_mfma_f32_16x16x32_bf16 v[192:195], v[100:103], v[28:31], v[192:195]
    v_mfma_f32_16x16x32_bf16 v[192:195], v[96:99], v[24:27], v[192:195]
    v_mfma_f32_16x16x32_bf16 v[132:135], v[88:91], v[24:27], v[132:135]
    v_mfma_f32_16x16x32_bf16 v[132:135], v[92:95], v[28:31], v[132:135]
    v_mfma_f32_16x16x32_bf16 v[128:131], v[84:87], v[28:31], v[128:131]
    v_mfma_f32_16x16x32_bf16 v[128:131], v[80:83], v[24:27], v[128:131]
    s_waitcnt lgkmcnt(4)
    v_mfma_f32_16x16x32_bf16 v[136:139], v[80:83], v[32:35], v[136:139]
    ds_read_b128 v[24:27], v2 offset:10240
    v_mfma_f32_16x16x32_bf16 v[136:139], v[84:87], v[36:39], v[136:139]
    ds_read_b128 v[28:31], v3 offset:10240
    v_mfma_f32_16x16x32_bf16 v[140:143], v[92:95], v[36:39], v[140:143]
    v_mfma_f32_16x16x32_bf16 v[140:143], v[88:91], v[32:35], v[140:143]
    v_mfma_f32_16x16x32_bf16 v[200:203], v[96:99], v[32:35], v[200:203]
    v_mfma_f32_16x16x32_bf16 v[200:203], v[100:103], v[36:39], v[200:203]
    v_mfma_f32_16x16x32_bf16 v[204:207], v[108:111], v[36:39], v[204:207]
    v_mfma_f32_16x16x32_bf16 v[204:207], v[104:107], v[32:35], v[204:207]
    s_waitcnt lgkmcnt(4)
    v_mfma_f32_16x16x32_bf16 v[212:215], v[104:107], v[40:43], v[212:215]
    ds_read_b128 v[32:35], v2 offset:12288
    v_mfma_f32_16x16x32_bf16 v[212:215], v[108:111], v[44:47], v[212:215]
    ds_read_b128 v[36:39], v3 offset:12288
    v_mfma_f32_16x16x32_bf16 v[208:211], v[100:103], v[44:47], v[208:211]
    v_mfma_f32_16x16x32_bf16 v[208:211], v[96:99], v[40:43], v[208:211]
    v_mfma_f32_16x16x32_bf16 v[148:151], v[88:91], v[40:43], v[148:151]
    v_cvt_pk_bf16_f32 v120, v120, v121
    v_cvt_pk_bf16_f32 v121, v122, v123
    v_mfma_f32_16x16x32_bf16 v[148:151], v[92:95], v[44:47], v[148:151]
    v_cvt_pk_bf16_f32 v122, v124, v125
    v_cvt_pk_bf16_f32 v123, v126, v127
    v_mfma_f32_16x16x32_bf16 v[144:147], v[84:87], v[44:47], v[144:147]
    v_pk_max_i16 v120, v120, 0
    v_pk_max_i16 v121, v121, 0
    v_mfma_f32_16x16x32_bf16 v[144:147], v[80:83], v[40:43], v[144:147]
    s_waitcnt lgkmcnt(4)
    v_pk_max_i16 v122, v122, 0
    v_pk_max_i16 v123, v123, 0
    v_mfma_f32_16x16x32_bf16 v[152:155], v[80:83], v[16:19], v[152:155]
    ds_read_b128 v[40:43], v2 offset:14336
    v_cvt_pk_bf16_f32 v184, v184, v185
    v_cvt_pk_bf16_f32 v185, v186, v187
    buffer_store_dwordx4 v[120:123], v1, s[20:23], s60 offen offset:0 sc1
    v_mfma_f32_16x16x32_bf16 v[152:155], v[84:87], v[20:23], v[152:155]
    ds_read_b128 v[44:47], v3 offset:14336
    v_cvt_pk_bf16_f32 v186, v188, v189
    v_cvt_pk_bf16_f32 v187, v190, v191
    v_mfma_f32_16x16x32_bf16 v[156:159], v[92:95], v[20:23], v[156:159]
    v_pk_max_i16 v184, v184, 0
    v_pk_max_i16 v185, v185, 0
    v_mfma_f32_16x16x32_bf16 v[156:159], v[88:91], v[16:19], v[156:159]
    v_pk_max_i16 v186, v186, 0
    v_pk_max_i16 v187, v187, 0
    v_mfma_f32_16x16x32_bf16 v[216:219], v[96:99], v[16:19], v[216:219]
    v_cvt_pk_bf16_f32 v192, v192, v193
    v_cvt_pk_bf16_f32 v193, v194, v195
    buffer_store_dwordx4 v[184:187], v1, s[20:23], s62 offen offset:0 sc1
    v_mfma_f32_16x16x32_bf16 v[216:219], v[100:103], v[20:23], v[216:219]
    v_cvt_pk_bf16_f32 v194, v196, v197
    v_cvt_pk_bf16_f32 v195, v198, v199
    v_mfma_f32_16x16x32_bf16 v[220:223], v[108:111], v[20:23], v[220:223]
    v_pk_max_i16 v192, v192, 0
    v_pk_max_i16 v193, v193, 0
    v_mfma_f32_16x16x32_bf16 v[220:223], v[104:107], v[16:19], v[220:223]
    s_waitcnt lgkmcnt(4)
    v_pk_max_i16 v194, v194, 0
    v_pk_max_i16 v195, v195, 0
    v_mfma_f32_16x16x32_bf16 v[228:231], v[104:107], v[24:27], v[228:231]
    v_cvt_pk_bf16_f32 v128, v128, v129
    v_cvt_pk_bf16_f32 v129, v130, v131
    buffer_store_dwordx4 v[192:195], v1, s[20:23], s62 offen offset:1024 sc1
    v_mfma_f32_16x16x32_bf16 v[228:231], v[108:111], v[28:31], v[228:231]
    v_cvt_pk_bf16_f32 v130, v132, v133
    v_cvt_pk_bf16_f32 v131, v134, v135
    v_mfma_f32_16x16x32_bf16 v[224:227], v[100:103], v[28:31], v[224:227]
    v_pk_max_i16 v128, v128, 0
    v_pk_max_i16 v129, v129, 0
    v_mfma_f32_16x16x32_bf16 v[224:227], v[96:99], v[24:27], v[224:227]
    v_pk_max_i16 v130, v130, 0
    v_pk_max_i16 v131, v131, 0
    v_mfma_f32_16x16x32_bf16 v[164:167], v[88:91], v[24:27], v[164:167]
    v_cvt_pk_bf16_f32 v136, v136, v137
    v_cvt_pk_bf16_f32 v137, v138, v139
    buffer_store_dwordx4 v[128:131], v1, s[20:23], s60 offen offset:1024 sc1
    v_mfma_f32_16x16x32_bf16 v[164:167], v[92:95], v[28:31], v[164:167]
    v_cvt_pk_bf16_f32 v138, v140, v141
    v_cvt_pk_bf16_f32 v139, v142, v143
    v_mfma_f32_16x16x32_bf16 v[160:163], v[84:87], v[28:31], v[160:163]
    v_pk_max_i16 v136, v136, 0
    v_pk_max_i16 v137, v137, 0
    v_mfma_f32_16x16x32_bf16 v[160:163], v[80:83], v[24:27], v[160:163]
    s_waitcnt lgkmcnt(0)
    v_pk_max_i16 v138, v138, 0
    v_pk_max_i16 v139, v139, 0
    v_mfma_f32_16x16x32_bf16 v[168:171], v[80:83], v[32:35], v[168:171]
    v_cvt_pk_bf16_f32 v200, v200, v201
    v_cvt_pk_bf16_f32 v201, v202, v203
    buffer_store_dwordx4 v[136:139], v1, s[20:23], s60 offen offset:2048 sc1
    v_mfma_f32_16x16x32_bf16 v[168:171], v[84:87], v[36:39], v[168:171]
    v_cvt_pk_bf16_f32 v202, v204, v205
    v_cvt_pk_bf16_f32 v203, v206, v207
    v_mfma_f32_16x16x32_bf16 v[172:175], v[92:95], v[36:39], v[172:175]
    v_pk_max_i16 v200, v200, 0
    v_pk_max_i16 v201, v201, 0
    v_mfma_f32_16x16x32_bf16 v[172:175], v[88:91], v[32:35], v[172:175]
    v_pk_max_i16 v202, v202, 0
    v_pk_max_i16 v203, v203, 0
    v_mfma_f32_16x16x32_bf16 v[232:235], v[96:99], v[32:35], v[232:235]
    v_cvt_pk_bf16_f32 v208, v208, v209
    v_cvt_pk_bf16_f32 v209, v210, v211
    buffer_store_dwordx4 v[200:203], v1, s[20:23], s62 offen offset:2048 sc1
    v_mfma_f32_16x16x32_bf16 v[232:235], v[100:103], v[36:39], v[232:235]
    v_cvt_pk_bf16_f32 v210, v212, v213
    v_cvt_pk_bf16_f32 v211, v214, v215
    v_mfma_f32_16x16x32_bf16 v[236:239], v[108:111], v[36:39], v[236:239]
    v_pk_max_i16 v208, v208, 0
    v_pk_max_i16 v209, v209, 0
    v_mfma_f32_16x16x32_bf16 v[236:239], v[104:107], v[32:35], v[236:239]
    v_pk_max_i16 v210, v210, 0
    v_pk_max_i16 v211, v211, 0
    v_mfma_f32_16x16x32_bf16 v[244:247], v[104:107], v[40:43], v[244:247]
    v_cvt_pk_bf16_f32 v144, v144, v145
    v_cvt_pk_bf16_f32 v145, v146, v147
    buffer_store_dwordx4 v[208:211], v1, s[20:23], s62 offen offset:3072 sc1
    v_mfma_f32_16x16x32_bf16 v[244:247], v[108:111], v[44:47], v[244:247]
    v_cvt_pk_bf16_f32 v146, v148, v149
    v_cvt_pk_bf16_f32 v147, v150, v151
    v_mfma_f32_16x16x32_bf16 v[240:243], v[100:103], v[44:47], v[240:243]
    v_pk_max_i16 v144, v144, 0
    v_pk_max_i16 v145, v145, 0
    v_mfma_f32_16x16x32_bf16 v[240:243], v[96:99], v[40:43], v[240:243]
    v_pk_max_i16 v146, v146, 0
    v_pk_max_i16 v147, v147, 0
    v_mfma_f32_16x16x32_bf16 v[180:183], v[88:91], v[40:43], v[180:183]
    v_cvt_pk_bf16_f32 v152, v152, v153
    v_cvt_pk_bf16_f32 v153, v154, v155
    buffer_store_dwordx4 v[144:147], v1, s[20:23], s60 offen offset:3072 sc1
    v_mfma_f32_16x16x32_bf16 v[180:183], v[92:95], v[44:47], v[180:183]
    v_cvt_pk_bf16_f32 v154, v156, v157
    v_cvt_pk_bf16_f32 v155, v158, v159
    v_mfma_f32_16x16x32_bf16 v[176:179], v[84:87], v[44:47], v[176:179]
    v_pk_max_i16 v152, v152, 0
    v_pk_max_i16 v153, v153, 0
    v_mfma_f32_16x16x32_bf16 v[176:179], v[80:83], v[40:43], v[176:179]
    v_pk_max_i16 v154, v154, 0
    v_pk_max_i16 v155, v155, 0
    buffer_store_dwordx4 v[152:155], v1, s[20:23], s61 offen offset:0 sc1
    v_cvt_pk_bf16_f32 v216, v216, v217
    v_cvt_pk_bf16_f32 v217, v218, v219
    v_cvt_pk_bf16_f32 v218, v220, v221
    v_cvt_pk_bf16_f32 v219, v222, v223
    v_pk_max_i16 v216, v216, 0
    v_pk_max_i16 v217, v217, 0
    v_pk_max_i16 v218, v218, 0
    v_pk_max_i16 v219, v219, 0
    buffer_store_dwordx4 v[216:219], v1, s[20:23], s63 offen offset:0 sc1
    v_cvt_pk_bf16_f32 v224, v224, v225
    v_cvt_pk_bf16_f32 v225, v226, v227
    v_cvt_pk_bf16_f32 v226, v228, v229
    v_cvt_pk_bf16_f32 v227, v230, v231
    v_pk_max_i16 v224, v224, 0
    v_pk_max_i16 v225, v225, 0
    v_pk_max_i16 v226, v226, 0
    v_pk_max_i16 v227, v227, 0
    buffer_store_dwordx4 v[224:227], v1, s[20:23], s63 offen offset:1024 sc1
    v_cvt_pk_bf16_f32 v160, v160, v161
    v_cvt_pk_bf16_f32 v161, v162, v163
    v_cvt_pk_bf16_f32 v162, v164, v165
    v_cvt_pk_bf16_f32 v163, v166, v167
    v_pk_max_i16 v160, v160, 0
    v_pk_max_i16 v161, v161, 0
    v_pk_max_i16 v162, v162, 0
    v_pk_max_i16 v163, v163, 0
    buffer_store_dwordx4 v[160:163], v1, s[20:23], s61 offen offset:1024 sc1
    v_cvt_pk_bf16_f32 v168, v168, v169
    v_cvt_pk_bf16_f32 v169, v170, v171
    v_cvt_pk_bf16_f32 v170, v172, v173
    v_cvt_pk_bf16_f32 v171, v174, v175
    v_pk_max_i16 v168, v168, 0
    v_pk_max_i16 v169, v169, 0
    v_pk_max_i16 v170, v170, 0
    v_pk_max_i16 v171, v171, 0
    buffer_store_dwordx4 v[168:171], v1, s[20:23], s61 offen offset:2048 sc1
    v_cvt_pk_bf16_f32 v232, v232, v233
    v_cvt_pk_bf16_f32 v233, v234, v235
    v_cvt_pk_bf16_f32 v234, v236, v237
    v_cvt_pk_bf16_f32 v235, v238, v239
    v_pk_max_i16 v232, v232, 0
    v_pk_max_i16 v233, v233, 0
    v_pk_max_i16 v234, v234, 0
    v_pk_max_i16 v235, v235, 0
    buffer_store_dwordx4 v[232:235], v1, s[20:23], s63 offen offset:2048 sc1
    v_cvt_pk_bf16_f32 v240, v240, v241
    v_cvt_pk_bf16_f32 v241, v242, v243
    v_cvt_pk_bf16_f32 v242, v244, v245
    v_cvt_pk_bf16_f32 v243, v246, v247
    v_pk_max_i16 v240, v240, 0
    v_pk_max_i16 v241, v241, 0
    v_pk_max_i16 v242, v242, 0
    v_pk_max_i16 v243, v243, 0
    buffer_store_dwordx4 v[240:243], v1, s[20:23], s63 offen offset:3072 sc1
    v_cvt_pk_bf16_f32 v176, v176, v177
    v_cvt_pk_bf16_f32 v177, v178, v179
    v_cvt_pk_bf16_f32 v178, v180, v181
    v_cvt_pk_bf16_f32 v179, v182, v183
    v_pk_max_i16 v176, v176, 0
    v_pk_max_i16 v177, v177, 0
    v_pk_max_i16 v178, v178, 0
    v_pk_max_i16 v179, v179, 0
    buffer_store_dwordx4 v[176:179], v1, s[20:23], s61 offen offset:3072 sc1
L_g1c_join:
    s_mov_b64 s[16:17], s[80:81]
    s_mov_b32 s18, 0x700000
    s_mov_b32 s19, 0x20000
    s_mul_i32 s57, s54, 917504
    s_mul_i32 s3, s56, 458752
    s_add_u32 s57, s57, s3
    s_lshl_b32 s63, s7, 12
    s_add_u32 s57, s57, s63
    s_mul_i32 s58, s56, 3670016
    s_lshl_b32 s3, s55, 8
    s_add_u32 s58, s58, s3
    s_lshl_b32 s3, s7, 15
    s_add_u32 s58, s58, s3
    s_mov_b32 s59, 0
    s_lshl_b32 s3, s95, 2
    s_lshl_b32 s98, 15, s3
    s_and_b32 s98, s98, 0xfffffff
    v_readlane_b32 s93, v118, s59
    s_add_u32 s59, s59, 1
    s_bitset1_b32 s98, s93
    s_lshl_b32 s60, s93, 14
    s_add_u32 s60, s60, s57
    s_lshl_b32 s61, s93, 17
    s_add_u32 s61, s61, s58
    v_readlane_b32 s93, v118, s59
    s_add_u32 s59, s59, 1
    s_bitset1_b32 s98, s93
    s_lshl_b32 s90, s93, 14
    s_add_u32 s90, s90, s57
    s_lshl_b32 s62, s93, 17
    s_add_u32 s62, s62, s58
    v_readlane_b32 s93, v118, s59
    s_add_u32 s59, s59, 1
    s_bitset1_b32 s98, s93
    s_lshl_b32 s91, s93, 14
    s_add_u32 s91, s91, s57
    s_lshl_b32 s92, s93, 17
    s_add_u32 s92, s92, s58
    s_add_u32 m0, s63, 16384
    s_nop 0
    buffer_load_dwordx4 v248, s[16:19], s62 offen offset:0 lds
    buffer_load_dwordx4 v249, s[16:19], s62 offen offset:1024 lds
    buffer_load_dwordx4 v250, s[16:19], s62 offen offset:2048 lds
    buffer_load_dwordx4 v251, s[16:19], s62 offen offset:3072 lds
    s_cmp_eq_u32 s74, 0
    s_cbranch_scc1 L_g1c_slow
    s_waitcnt vmcnt(4)
    s_mov_b64 exec, 1
    buffer_store_dword v253, v252, s[20:23], s1 offen
    s_mov_b64 exec, -1
L_g2_c:
    s_add_u32 m0, s63, 32768
    s_nop 0
    buffer_load_dwordx4 v248, s[16:19], s92 offen offset:0 lds
    buffer_load_dwordx4 v249, s[16:19], s92 offen offset:1024 lds
    buffer_load_dwordx4 v250, s[16:19], s92 offen offset:2048 lds
    buffer_load_dwordx4 v251, s[16:19], s92 offen offset:3072 lds
    s_mov_b32 s51, 0
L_hpoll:
    buffer_load_dword v16, v14, s[20:23], 0 offen sc1
    s_waitcnt vmcnt(0)
    v_cmp_ne_u32 vcc, 1, v16
    s_add_u32 s51, s51, 1
    s_orn2_b32 s94, 0xf0000000, vcc_lo
    s_and_b32 s3, vcc_lo, s98
    s_cbranch_scc0 L_hpolldone
    s_sleep 2
    s_cmp_lt_u32 s51, 200000
    s_cbranch_scc1 L_hpoll
L_hpolldone:
    s_add_u32 m0, s63, 49152
    s_nop 0
    buffer_load_dwordx4 v1, s[20:23], s60 offen offset:0 sc1 lds
    buffer_load_dwordx4 v1, s[20:23], s60 offen offset:1024 sc1 lds
    buffer_load_dwordx4 v1, s[20:23], s60 offen offset:2048 sc1 lds
    buffer_load_dwordx4 v1, s[20:23], s60 offen offset:3072 sc1 lds
    s_add_u32 m0, s63, 65536
    s_nop 0
    buffer_load_dwordx4 v1, s[20:23], s90 offen offset:0 sc1 lds
    buffer_load_dwordx4 v1, s[20:23], s90 offen offset:1024 sc1 lds
    buffer_load_dwordx4 v1, s[20:23], s90 offen offset:2048 sc1 lds
    buffer_load_dwordx4 v1, s[20:23], s90 offen offset:3072 sc1 lds
    s_add_u32 m0, s63, 81920
    s_nop 0
    buffer_load_dwordx4 v1, s[20:23], s91 offen offset:0 sc1 lds
    buffer_load_dwordx4 v1, s[20:23], s91 offen offset:1024 sc1 lds
    buffer_load_dwordx4 v1, s[20:23], s91 offen offset:2048 sc1 lds
    buffer_load_dwordx4 v1, s[20:23], s91 offen offset:3072 sc1 lds
    s_lshl_b32 s3, s7, 2
    s_add_u32 s3, s3, 163460
    v_mov_b32 v16, s3
    v_mov_b32 v17, s94
    ds_write_b32 v16, v17
    s_waitcnt vmcnt(8) lgkmcnt(0)
    s_barrier
    ds_read_b64_tr_b16 v[48:49], v10 offset:0
    ds_read_b128 v[16:19], v8 offset:0
    ds_read_b64_tr_b16 v[50:51], v10 offset:4096
    ds_read_b128 v[32:35], v8 offset:8192
    ds_read_b64_tr_b16 v[52:53], v10 offset:8192
    ds_read_b128 v[20:23], v8 offset:1024
    ds_read_b64_tr_b16 v[54:55], v10 offset:12288
    ds_read_b128 v[36:39], v8 offset:9216
    ds_read_b64_tr_b16 v[56:57], v11 offset:0
    ds_read_b128 v[24:27], v9 offset:0
    ds_read_b64_tr_b16 v[58:59], v11 offset:4096
    ds_read_b128 v[40:43], v9 offset:8192
    ds_read_b64_tr_b16 v[60:61], v11 offset:8192
    ds_read_b128 v[28:31], v9 offset:1024
    ds_read_b64_tr_b16 v[62:63], v11 offset:12288
    ds_read_b128 v[44:47], v9 offset:9216
    ds_read_b64_tr_b16 v[64:65], v12 offset:0
    ds_read_b64_tr_b16 v[66:67], v12 offset:4096
    ds_read_b64_tr_b16 v[68:69], v12 offset:8192
    ds_read_b64_tr_b16 v[70:71], v12 offset:12288
    ds_read_b64_tr_b16 v[72:73], v13 offset:0
    ds_read_b64_tr_b16 v[74:75], v13 offset:4096
    ds_read_b64_tr_b16 v[76:77], v13 offset:8192
    ds_read_b64_tr_b16 v[78:79], v13 offset:12288
    s_waitcnt lgkmcnt(8)
    v_mfma_f32_16x16x32_bf16 v[184:187], v[48:51], v[16:19], 0
    s_lshr_b32 s92, s52, 1
    v_mfma_f32_16x16x32_bf16 v[184:187], v[52:55], v[32:35], v[184:187]
    s_sub_u32 s92, s92, 1
    v_mfma_f32_16x16x32_bf16 v[188:191], v[52:55], v[36:39], 0
    v_mfma_f32_16x16x32_bf16 v[188:191], v[48:51], v[20:23], v[188:191]
    v_mfma_f32_16x16x32_bf16 v[216:219], v[48:51], v[24:27], 0
    v_mfma_f32_16x16x32_bf16 v[216:219], v[52:55], v[40:43], v[216:219]
    v_mfma_f32_16x16x32_bf16 v[220:223], v[52:55], v[44:47], 0
    s_waitcnt vmcnt(4) lgkmcnt(0)
    s_barrier
    v_mfma_f32_16x16x32_bf16 v[220:223], v[48:51], v[28:31], v[220:223]
    ds_read_b64_tr_b16 v[152:153], v10 offset:16384
    v_mfma_f32_16x16x32_bf16 v[228:231], v[56:59], v[28:31], 0
    ds_read_b128 v[120:123], v8 offset:16384
    v_mfma_f32_16x16x32_bf16 v[228:231], v[60:63], v[44:47], v[228:231]
    ds_read_b64_tr_b16 v[154:155], v10 offset:20480
    v_mfma_f32_16x16x32_bf16 v[224:227], v[60:63], v[40:43], 0
    ds_read_b128 v[136:139], v8 offset:24576
    v_mfma_f32_16x16x32_bf16 v[224:227], v[56:59], v[24:27], v[224:227]
    ds_read_b64_tr_b16 v[156:157], v10 offset:24576
    v_mfma_f32_16x16x32_bf16 v[196:199], v[56:59], v[20:23], 0
    ds_read_b128 v[124:127], v8 offset:17408
    v_mfma_f32_16x16x32_bf16 v[196:199], v[60:63], v[36:39], v[196:199]
    ds_read_b64_tr_b16 v[158:159], v10 offset:28672
    v_mfma_f32_16x16x32_bf16 v[192:195], v[60:63], v[32:35], 0
    ds_read_b128 v[140:143], v8 offset:25600
    v_mfma_f32_16x16x32_bf16 v[192:195], v[56:59], v[16:19], v[192:195]
    ds_read_b64_tr_b16 v[160:161], v11 offset:16384
    v_mfma_f32_16x16x32_bf16 v[200:203], v[64:67], v[16:19], 0
    ds_read_b128 v[128:131], v9 offset:16384
    v_mfma_f32_16x16x32_bf16 v[200:203], v[68:71], v[32:35], v[200:203]
    ds_read_b64_tr_b16 v[162:163], v11 offset:20480
    v_mfma_f32_16x16x32_bf16 v[204:207], v[68:71], v[36:39], 0
    ds_read_b128 v[144:147], v9 offset:24576
    v_mfma_f32_16x16x32_bf16 v[204:207], v[64:67], v[20:23], v[204:207]
    ds_read_b64_tr_b16 v[164:165], v11 offset:24576
    v_mfma_f32_16x16x32_bf16 v[232:235], v[64:67], v[24:27], 0
    ds_read_b128 v[132:135], v9 offset:17408
    v_mfma_f32_16x16x32_bf16 v[232:235], v[68:71], v[40:43], v[232:235]
    ds_read_b64_tr_b16 v[166:167], v11 offset:28672
    v_mfma_f32_16x16x32_bf16 v[236:239], v[68:71], v[44:47], 0
    ds_read_b128 v[148:151], v9 offset:25600
    v_mfma_f32_16x16x32_bf16 v[236:239], v[64:67], v[28:31], v[236:239]
    ds_read_b64_tr_b16 v[168:169], v12 offset:16384
    v_mfma_f32_16x16x32_bf16 v[244:247], v[72:75], v[28:31], 0
    ds_read_b64_tr_b16 v[170:171], v12 offset:20480
    v_mfma_f32_16x16x32_bf16 v[244:247], v[76:79], v[44:47], v[244:247]
    ds_read_b64_tr_b16 v[172:173], v12 offset:24576
    v_mfma_f32_16x16x32_bf16 v[240:243], v[76:79], v[40:43], 0
    ds_read_b64_tr_b16 v[174:175], v12 offset:28672
    v_mfma_f32_16x16x32_bf16 v[240:243], v[72:75], v[24:27], v[240:243]
    ds_read_b64_tr_b16 v[176:177], v13 offset:16384
    v_mfma_f32_16x16x32_bf16 v[212:215], v[72:75], v[20:23], 0
    ds_read_b64_tr_b16 v[178:179], v13 offset:20480
    v_mfma_f32_16x16x32_bf16 v[212:215], v[76:79], v[36:39], v[212:215]
    ds_read_b64_tr_b16 v[180:181], v13 offset:24576
    v_mfma_f32_16x16x32_bf16 v[208:211], v[76:79], v[32:35], 0
    ds_read_b64_tr_b16 v[182:183], v13 offset:28672
    v_mfma_f32_16x16x32_bf16 v[208:211], v[72:75], v[16:19], v[208:211]
    s_branch L_g2c_entry
    .p2align 6
L_g2c_loop:
    s_waitcnt lgkmcnt(8)
    v_mfma_f32_16x16x32_bf16 v[184:187], v[48:51], v[16:19], v[184:187]
    v_mfma_f32_16x16x32_bf16 v[184:187], v[52:55], v[32:35], v[184:187]
    v_mfma_f32_16x16x32_bf16 v[188:191], v[52:55], v[36:39], v[188:191]
    v_mfma_f32_16x16x32_bf16 v[188:191], v[48:51], v[20:23], v[188:191]
    v_mfma_f32_16x16x32_bf16 v[216:219], v[48:51], v[24:27], v[216:219]
    v_mfma_f32_16x16x32_bf16 v[216:219], v[52:55], v[40:43], v[216:219]
    v_mfma_f32_16x16x32_bf16 v[220:223], v[52:55], v[44:47], v[220:223]
    s_waitcnt vmcnt(0) lgkmcnt(0)
    s_barrier
    v_mfma_f32_16x16x32_bf16 v[220:223], v[48:51], v[28:31], v[220:223]
    ds_read_b64_tr_b16 v[152:153], v10 offset:16384
    v_mfma_f32_16x16x32_bf16 v[228:231], v[56:59], v[28:31], v[228:231]
    ds_read_b128 v[120:123], v8 offset:16384
    v_mfma_f32_16x16x32_bf16 v[228:231], v[60:63], v[44:47], v[228:231]
    ds_read_b64_tr_b16 v[154:155], v10 offset:20480
    v_mfma_f32_16x16x32_bf16 v[224:227], v[60:63], v[40:43], v[224:227]
    ds_read_b128 v[136:139], v8 offset:24576
    v_mfma_f32_16x16x32_bf16 v[224:227], v[56:59], v[24:27], v[224:227]
    ds_read_b64_tr_b16 v[156:157], v10 offset:24576
    v_mfma_f32_16x16x32_bf16 v[196:199], v[56:59], v[20:23], v[196:199]
    ds_read_b128 v[124:127], v8 offset:17408
    v_mfma_f32_16x16x32_bf16 v[196:199], v[60:63], v[36:39], v[196:199]
    ds_read_b64_tr_b16 v[158:159], v10 offset:28672
    v_mfma_f32_16x16x32_bf16 v[192:195], v[60:63], v[32:35], v[192:195]
    ds_read_b128 v[140:143], v8 offset:25600
    v_mfma_f32_16x16x32_bf16 v[192:195], v[56:59], v[16:19], v[192:195]
    ds_read_b64_tr_b16 v[160:161], v11 offset:16384
    v_mfma_f32_16x16x32_bf16 v[200:203], v[64:67], v[16:19], v[200:203]
    ds_read_b128 v[128:131], v9 offset:16384
    v_mfma_f32_16x16x32_bf16 v[200:203], v[68:71], v[32:35], v[200:203]
    ds_read_b64_tr_b16 v[162:163], v11 offset:20480
    v_mfma_f32_16x16x32_bf16 v[204:207], v[68:71], v[36:39], v[204:207]
    ds_read_b128 v[144:147], v9 offset:24576
    v_mfma_f32_16x16x32_bf16 v[204:207], v[64:67], v[20:23], v[204:207]
    ds_read_b64_tr_b16 v[164:165], v11 offset:24576
    v_mfma_f32_16x16x32_bf16 v[232:235], v[64:67], v[24:27], v[232:235]
    ds_read_b128 v[132:135], v9 offset:17408
    v_mfma_f32_16x16x32_bf16 v[232:235], v[68:71], v[40:43], v[232:235]
    ds_read_b64_tr_b16 v[166:167], v11 offset:28672
    v_mfma_f32_16x16x32_bf16 v[236:239], v[68:71], v[44:47], v[236:239]
    ds_read_b128 v[148:151], v9 offset:25600
    v_mfma_f32_16x16x32_bf16 v[236:239], v[64:67], v[28:31], v[236:239]
    ds_read_b64_tr_b16 v[168:169], v12 offset:16384
    v_mfma_f32_16x16x32_bf16 v[244:247], v[72:75], v[28:31], v[244:247]
    ds_read_b64_tr_b16 v[170:171], v12 offset:20480
    v_mfma_f32_16x16x32_bf16 v[244:247], v[76:79], v[44:47], v[244:247]
    ds_read_b64_tr_b16 v[172:173], v12 offset:24576
    v_mfma_f32_16x16x32_bf16 v[240:243], v[76:79], v[40:43], v[240:243]
    ds_read_b64_tr_b16 v[174:175], v12 offset:28672
    v_mfma_f32_16x16x32_bf16 v[240:243], v[72:75], v[24:27], v[240:243]
    ds_read_b64_tr_b16 v[176:177], v13 offset:16384
    v_mfma_f32_16x16x32_bf16 v[212:215], v[72:75], v[20:23], v[212:215]
    ds_read_b64_tr_b16 v[178:179], v13 offset:20480
    v_mfma_f32_16x16x32_bf16 v[212:215], v[76:79], v[36:39], v[212:215]
    ds_read_b64_tr_b16 v[180:181], v13 offset:24576
    v_mfma_f32_16x16x32_bf16 v[208:211], v[76:79], v[32:35], v[208:211]
    ds_read_b64_tr_b16 v[182:183], v13 offset:28672
    v_mfma_f32_16x16x32_bf16 v[208:211], v[72:75], v[16:19], v[208:211]
L_g2c_entry:
    s_waitcnt lgkmcnt(8)
    v_mfma_f32_16x16x32_bf16 v[184:187], v[152:155], v[120:123], v[184:187]
    s_sub_u32 s92, s92, 1
    v_mfma_f32_16x16x32_bf16 v[184:187], v[156:159], v[136:139], v[184:187]
    v_mfma_f32_16x16x32_bf16 v[188:191], v[156:159], v[140:143], v[188:191]
    v_mfma_f32_16x16x32_bf16 v[188:191], v[152:155], v[124:127], v[188:191]
    v_mfma_f32_16x16x32_bf16 v[216:219], v[152:155], v[128:131], v[216:219]
    v_mfma_f32_16x16x32_bf16 v[216:219], v[156:159], v[144:147], v[216:219]
    v_mfma_f32_16x16x32_bf16 v[220:223], v[156:159], v[148:151], v[220:223]
    s_waitcnt vmcnt(0) lgkmcnt(0)
    s_barrier
    v_mfma_f32_16x16x32_bf16 v[220:223], v[152:155], v[132:135], v[220:223]
    ds_read_b64_tr_b16 v[48:49], v10 offset:32768
    v_mfma_f32_16x16x32_bf16 v[228:231], v[160:163], v[132:135], v[228:231]
    ds_read_b128 v[16:19], v8 offset:32768
    v_mfma_f32_16x16x32_bf16 v[228:231], v[164:167], v[148:151], v[228:231]
    ds_read_b64_tr_b16 v[50:51], v10 offset:36864
    v_mfma_f32_16x16x32_bf16 v[224:227], v[164:167], v[144:147], v[224:227]
    ds_read_b128 v[32:35], v8 offset:40960
    v_mfma_f32_16x16x32_bf16 v[224:227], v[160:163], v[128:131], v[224:227]
    ds_read_b64_tr_b16 v[52:53], v10 offset:40960
    v_mfma_f32_16x16x32_bf16 v[196:199], v[160:163], v[124:127], v[196:199]
    ds_read_b128 v[20:23], v8 offset:33792
    v_mfma_f32_16x16x32_bf16 v[196:199], v[164:167], v[140:143], v[196:199]
    ds_read_b64_tr_b16 v[54:55], v10 offset:45056
    v_mfma_f32_16x16x32_bf16 v[192:195], v[164:167], v[136:139], v[192:195]
    ds_read_b128 v[36:39], v8 offset:41984
    v_mfma_f32_16x16x32_bf16 v[192:195], v[160:163], v[120:123], v[192:195]
    ds_read_b64_tr_b16 v[56:57], v11 offset:32768
    v_mfma_f32_16x16x32_bf16 v[200:203], v[168:171], v[120:123], v[200:203]
    ds_read_b128 v[24:27], v9 offset:32768
    v_mfma_f32_16x16x32_bf16 v[200:203], v[172:175], v[136:139], v[200:203]
    ds_read_b64_tr_b16 v[58:59], v11 offset:36864
    v_mfma_f32_16x16x32_bf16 v[204:207], v[172:175], v[140:143], v[204:207]
    ds_read_b128 v[40:43], v9 offset:40960
    v_mfma_f32_16x16x32_bf16 v[204:207], v[168:171], v[124:127], v[204:207]
    ds_read_b64_tr_b16 v[60:61], v11 offset:40960
    v_mfma_f32_16x16x32_bf16 v[232:235], v[168:171], v[128:131], v[232:235]
    ds_read_b128 v[28:31], v9 offset:33792
    v_mfma_f32_16x16x32_bf16 v[232:235], v[172:175], v[144:147], v[232:235]
    ds_read_b64_tr_b16 v[62:63], v11 offset:45056
    v_mfma_f32_16x16x32_bf16 v[236:239], v[172:175], v[148:151], v[236:239]
    ds_read_b128 v[44:47], v9 offset:41984
    v_mfma_f32_16x16x32_bf16 v[236:239], v[168:171], v[132:135], v[236:239]
    ds_read_b64_tr_b16 v[64:65], v12 offset:32768
    v_mfma_f32_16x16x32_bf16 v[244:247], v[176:179], v[132:135], v[244:247]
    ds_read_b64_tr_b16 v[66:67], v12 offset:36864
    v_mfma_f32_16x16x32_bf16 v[244:247], v[180:183], v[148:151], v[244:247]
    ds_read_b64_tr_b16 v[68:69], v12 offset:40960
    v_mfma_f32_16x16x32_bf16 v[240:243], v[180:183], v[144:147], v[240:243]
    ds_read_b64_tr_b16 v[70:71], v12 offset:45056
    v_mfma_f32_16x16x32_bf16 v[240:243], v[176:179], v[128:131], v[240:243]
    ds_read_b64_tr_b16 v[72:73], v13 offset:32768
    v_mfma_f32_16x16x32_bf16 v[212:215], v[176:179], v[124:127], v[212:215]
    ds_read_b64_tr_b16 v[74:75], v13 offset:36864
    v_mfma_f32_16x16x32_bf16 v[212:215], v[180:183], v[140:143], v[212:215]
    ds_read_b64_tr_b16 v[76:77], v13 offset:40960
    v_mfma_f32_16x16x32_bf16 v[208:211], v[180:183], v[136:139], v[208:211]
    ds_read_b64_tr_b16 v[78:79], v13 offset:45056
    v_mfma_f32_16x16x32_bf16 v[208:211], v[176:179], v[120:123], v[208:211]
    s_cbranch_scc1 L_g2c_last
    s_waitcnt lgkmcnt(8)
    v_mfma_f32_16x16x32_bf16 v[184:187], v[48:51], v[16:19], v[184:187]
    v_mfma_f32_16x16x32_bf16 v[184:187], v[52:55], v[32:35], v[184:187]
    v_mfma_f32_16x16x32_bf16 v[188:191], v[52:55], v[36:39], v[188:191]
    v_mfma_f32_16x16x32_bf16 v[188:191], v[48:51], v[20:23], v[188:191]
    v_mfma_f32_16x16x32_bf16 v[216:219], v[48:51], v[24:27], v[216:219]
    v_mfma_f32_16x16x32_bf16 v[216:219], v[52:55], v[40:43], v[216:219]
    v_mfma_f32_16x16x32_bf16 v[220:223], v[52:55], v[44:47], v[220:223]
    s_waitcnt vmcnt(0) lgkmcnt(0)
    s_barrier
    v_mfma_f32_16x16x32_bf16 v[220:223], v[48:51], v[28:31], v[220:223]
    ds_read_b64_tr_b16 v[152:153], v114 offset:0
    v_mfma_f32_16x16x32_bf16 v[228:231], v[56:59], v[28:31], v[228:231]
    ds_read_b128 v[120:123], v112 offset:0
    v_mfma_f32_16x16x32_bf16 v[228:231], v[60:63], v[44:47], v[228:231]
    ds_read_b64_tr_b16 v[154:155], v114 offset:4096
    v_mfma_f32_16x16x32_bf16 v[224:227], v[60:63], v[40:43], v[224:227]
    ds_read_b128 v[136:139], v112 offset:8192
    v_mfma_f32_16x16x32_bf16 v[224:227], v[56:59], v[24:27], v[224:227]
    ds_read_b64_tr_b16 v[156:157], v114 offset:8192
    v_mfma_f32_16x16x32_bf16 v[196:199], v[56:59], v[20:23], v[196:199]
    ds_read_b128 v[124:127], v112 offset:1024
    v_mfma_f32_16x16x32_bf16 v[196:199], v[60:63], v[36:39], v[196:199]
    ds_read_b64_tr_b16 v[158:159], v114 offset:12288
    v_mfma_f32_16x16x32_bf16 v[192:195], v[60:63], v[32:35], v[192:195]
    ds_read_b128 v[140:143], v112 offset:9216
    v_mfma_f32_16x16x32_bf16 v[192:195], v[56:59], v[16:19], v[192:195]
    ds_read_b64_tr_b16 v[160:161], v115 offset:0
    v_mfma_f32_16x16x32_bf16 v[200:203], v[64:67], v[16:19], v[200:203]
    ds_read_b128 v[128:131], v113 offset:0
    v_mfma_f32_16x16x32_bf16 v[200:203], v[68:71], v[32:35], v[200:203]
    ds_read_b64_tr_b16 v[162:163], v115 offset:4096
    v_mfma_f32_16x16x32_bf16 v[204:207], v[68:71], v[36:39], v[204:207]
    ds_read_b128 v[144:147], v113 offset:8192
    v_mfma_f32_16x16x32_bf16 v[204:207], v[64:67], v[20:23], v[204:207]
    ds_read_b64_tr_b16 v[164:165], v115 offset:8192
    v_mfma_f32_16x16x32_bf16 v[232:235], v[64:67], v[24:27], v[232:235]
    ds_read_b128 v[132:135], v113 offset:1024
    v_mfma_f32_16x16x32_bf16 v[232:235], v[68:71], v[40:43], v[232:235]
    ds_read_b64_tr_b16 v[166:167], v115 offset:12288
    v_mfma_f32_16x16x32_bf16 v[236:239], v[68:71], v[44:47], v[236:239]
    ds_read_b128 v[148:151], v113 offset:9216
    v_mfma_f32_16x16x32_bf16 v[236:239], v[64:67], v[28:31], v[236:239]
    ds_read_b64_tr_b16 v[168:169], v116 offset:0
    v_mfma_f32_16x16x32_bf16 v[244:247], v[72:75], v[28:31], v[244:247]
    ds_read_b64_tr_b16 v[170:171], v116 offset:4096
    v_mfma_f32_16x16x32_bf16 v[244:247], v[76:79], v[44:47], v[244:247]
    ds_read_b64_tr_b16 v[172:173], v116 offset:8192
    v_mfma_f32_16x16x32_bf16 v[240:243], v[76:79], v[40:43], v[240:243]
    ds_read_b64_tr_b16 v[174:175], v116 offset:12288
    v_mfma_f32_16x16x32_bf16 v[240:243], v[72:75], v[24:27], v[240:243]
    ds_read_b64_tr_b16 v[176:177], v117 offset:0
    v_mfma_f32_16x16x32_bf16 v[212:215], v[72:75], v[20:23], v[212:215]
    ds_read_b64_tr_b16 v[178:179], v117 offset:4096
    v_mfma_f32_16x16x32_bf16 v[212:215], v[76:79], v[36:39], v[212:215]
    ds_read_b64_tr_b16 v[180:181], v117 offset:8192
    v_mfma_f32_16x16x32_bf16 v[208:211], v[76:79], v[32:35], v[208:211]
    ds_read_b64_tr_b16 v[182:183], v117 offset:12288
    v_mfma_f32_16x16x32_bf16 v[208:211], v[72:75], v[16:19], v[208:211]
    s_waitcnt lgkmcnt(8)
    v_mfma_f32_16x16x32_bf16 v[184:187], v[152:155], v[120:123], v[184:187]
    s_sub_u32 s92, s92, 1
    v_mfma_f32_16x16x32_bf16 v[184:187], v[156:159], v[136:139], v[184:187]
    v_mfma_f32_16x16x32_bf16 v[188:191], v[156:159], v[140:143], v[188:191]
    v_mfma_f32_16x16x32_bf16 v[188:191], v[152:155], v[124:127], v[188:191]
    v_mfma_f32_16x16x32_bf16 v[216:219], v[152:155], v[128:131], v[216:219]
    v_mfma_f32_16x16x32_bf16 v[216:219], v[156:159], v[144:147], v[216:219]
    v_mfma_f32_16x16x32_bf16 v[220:223], v[156:159], v[148:151], v[220:223]
    s_waitcnt vmcnt(0) lgkmcnt(0)
    s_barrier
    v_mfma_f32_16x16x32_bf16 v[220:223], v[152:155], v[132:135], v[220:223]
    ds_read_b64_tr_b16 v[48:49], v10 offset:0
    v_mfma_f32_16x16x32_bf16 v[228:231], v[160:163], v[132:135], v[228:231]
    ds_read_b128 v[16:19], v8 offset:0
    v_mfma_f32_16x16x32_bf16 v[228:231], v[164:167], v[148:151], v[228:231]
    ds_read_b64_tr_b16 v[50:51], v10 offset:4096
    v_mfma_f32_16x16x32_bf16 v[224:227], v[164:167], v[144:147], v[224:227]
    ds_read_b128 v[32:35], v8 offset:8192
    v_mfma_f32_16x16x32_bf16 v[224:227], v[160:163], v[128:131], v[224:227]
    ds_read_b64_tr_b16 v[52:53], v10 offset:8192
    v_mfma_f32_16x16x32_bf16 v[196:199], v[160:163], v[124:127], v[196:199]
    ds_read_b128 v[20:23], v8 offset:1024
    v_mfma_f32_16x16x32_bf16 v[196:199], v[164:167], v[140:143], v[196:199]
    ds_read_b64_tr_b16 v[54:55], v10 offset:12288
    v_mfma_f32_16x16x32_bf16 v[192:195], v[164:167], v[136:139], v[192:195]
    ds_read_b128 v[36:39], v8 offset:9216
    v_mfma_f32_16x16x32_bf16 v[192:195], v[160:163], v[120:123], v[192:195]
    ds_read_b64_tr_b16 v[56:57], v11 offset:0
    v_mfma_f32_16x16x32_bf16 v[200:203], v[168:171], v[120:123], v[200:203]
    ds_read_b128 v[24:27], v9 offset:0
    v_mfma_f32_16x16x32_bf16 v[200:203], v[172:175], v[136:139], v[200:203]
    ds_read_b64_tr_b16 v[58:59], v11 offset:4096
    v_mfma_f32_16x16x32_bf16 v[204:207], v[172:175], v[140:143], v[204:207]
    ds_read_b128 v[40:43], v9 offset:8192
    v_mfma_f32_16x16x32_bf16 v[204:207], v[168:171], v[124:127], v[204:207]
    ds_read_b64_tr_b16 v[60:61], v11 offset:8192
    v_mfma_f32_16x16x32_bf16 v[232:235], v[168:171], v[128:131], v[232:235]
    ds_read_b128 v[28:31], v9 offset:1024
    v_mfma_f32_16x16x32_bf16 v[232:235], v[172:175], v[144:147], v[232:235]
    ds_read_b64_tr_b16 v[62:63], v11 offset:12288
    v_mfma_f32_16x16x32_bf16 v[236:239], v[172:175], v[148:151], v[236:239]
    ds_read_b128 v[44:47], v9 offset:9216
    v_mfma_f32_16x16x32_bf16 v[236:239], v[168:171], v[132:135], v[236:239]
    ds_read_b64_tr_b16 v[64:65], v12 offset:0
    v_mfma_f32_16x16x32_bf16 v[244:247], v[176:179], v[132:135], v[244:247]
    ds_read_b64_tr_b16 v[66:67], v12 offset:4096
    v_mfma_f32_16x16x32_bf16 v[244:247], v[180:183], v[148:151], v[244:247]
    ds_read_b64_tr_b16 v[68:69], v12 offset:8192
    v_mfma_f32_16x16x32_bf16 v[240:243], v[180:183], v[144:147], v[240:243]
    ds_read_b64_tr_b16 v[70:71], v12 offset:12288
    v_mfma_f32_16x16x32_bf16 v[240:243], v[176:179], v[128:131], v[240:243]
    ds_read_b64_tr_b16 v[72:73], v13 offset:0
    v_mfma_f32_16x16x32_bf16 v[212:215], v[176:179], v[124:127], v[212:215]
    ds_read_b64_tr_b16 v[74:75], v13 offset:4096
    v_mfma_f32_16x16x32_bf16 v[212:215], v[180:183], v[140:143], v[212:215]
    ds_read_b64_tr_b16 v[76:77], v13 offset:8192
    v_mfma_f32_16x16x32_bf16 v[208:211], v[180:183], v[136:139], v[208:211]
    ds_read_b64_tr_b16 v[78:79], v13 offset:12288
    v_mfma_f32_16x16x32_bf16 v[208:211], v[176:179], v[120:123], v[208:211]
    s_cbranch_scc0 L_g2c_loop
L_g2c_last:
    s_waitcnt lgkmcnt(8)
    v_mfma_f32_16x16x32_bf16 v[216:219], v[48:51], v[24:27], v[216:219]
    s_lshl_b32 s59, s2, 14
    s_lshl_b32 s3, s7, 12
    v_mfma_f32_16x16x32_bf16 v[216:219], v[52:55], v[40:43], v[216:219]
    s_add_u32 s59, s59, s3
    s_add_u32 s59, s59, 0x1800000
    v_mfma_f32_16x16x32_bf16 v[220:223], v[52:55], v[44:47], v[220:223]
    s_xor_b32 s60, s59, 0x4000
    s_lshl_b32 s61, s54, 2
    v_mfma_f32_16x16x32_bf16 v[220:223], v[48:51], v[28:31], v[220:223]
    s_waitcnt lgkmcnt(0)
    s_lshl_b32 s3, s56, 1
    s_add_u32 s61, s61, s3
    v_mfma_f32_16x16x32_bf16 v[224:227], v[56:59], v[24:27], v[224:227]
    s_add_u32 s61, s61, s77
    s_mov_b32 s94, 65536
    v_mfma_f32_16x16x32_bf16 v[224:227], v[60:63], v[40:43], v[224:227]
    s_cmp_eq_u32 s56, 1
    s_cselect_b32 s94, 114688, s94
    v_mfma_f32_16x16x32_bf16 v[228:231], v[60:63], v[44:47], v[228:231]
    s_lshl_b32 s63, s77, 8
    s_add_u32 s63, s63, s94
    v_mfma_f32_16x16x32_bf16 v[228:231], v[56:59], v[28:31], v[228:231]
    v_and_b32 v96, 15, v0
    v_lshrrev_b32 v97, 4, v0
    v_mfma_f32_16x16x32_bf16 v[232:235], v[64:67], v[24:27], v[232:235]
    v_lshl_add_u32 v101, v96, 3, s63
    s_lshl_b32 s3, s0, 3
    v_mfma_f32_16x16x32_bf16 v[232:235], v[68:71], v[40:43], v[232:235]
    v_lshrrev_b32 v98, 1, v97
    v_or_b32 v98, s3, v98
    v_mfma_f32_16x16x32_bf16 v[236:239], v[68:71], v[44:47], v[236:239]
    v_cvt_pk_bf16_f32 v216, v216, v217
    v_cvt_pk_bf16_f32 v217, v218, v219
    v_mfma_f32_16x16x32_bf16 v[236:239], v[64:67], v[28:31], v[236:239]
    v_cvt_pk_bf16_f32 v218, v220, v221
    v_cvt_pk_bf16_f32 v219, v222, v223
    v_mfma_f32_16x16x32_bf16 v[240:243], v[72:75], v[24:27], v[240:243]
    buffer_store_dwordx4 v[216:219], v1, s[20:23], s59 offen offset:0 sc1
    v_mfma_f32_16x16x32_bf16 v[240:243], v[76:79], v[40:43], v[240:243]
    v_xor_b32 v98, v98, v96
    v_and_b32 v99, 1, v97
    v_mfma_f32_16x16x32_bf16 v[244:247], v[76:79], v[44:47], v[244:247]
    v_cvt_pk_bf16_f32 v224, v224, v225
    v_cvt_pk_bf16_f32 v225, v226, v227
    v_mfma_f32_16x16x32_bf16 v[244:247], v[72:75], v[28:31], v[244:247]
    v_cvt_pk_bf16_f32 v226, v228, v229
    v_cvt_pk_bf16_f32 v227, v230, v231
    v_mfma_f32_16x16x32_bf16 v[184:187], v[48:51], v[16:19], v[184:187]
    buffer_store_dwordx4 v[224:227], v1, s[20:23], s59 offen offset:1024 sc1
    v_mfma_f32_16x16x32_bf16 v[184:187], v[52:55], v[32:35], v[184:187]
    v_lshlrev_b32 v99, 3, v99
    v_lshl_add_u32 v99, v96, 8, v99
    v_mfma_f32_16x16x32_bf16 v[188:191], v[52:55], v[36:39], v[188:191]
    v_cvt_pk_bf16_f32 v232, v232, v233
    v_cvt_pk_bf16_f32 v233, v234, v235
    v_mfma_f32_16x16x32_bf16 v[188:191], v[48:51], v[20:23], v[188:191]
    v_cvt_pk_bf16_f32 v234, v236, v237
    v_cvt_pk_bf16_f32 v235, v238, v239
    v_mfma_f32_16x16x32_bf16 v[192:195], v[56:59], v[16:19], v[192:195]
    buffer_store_dwordx4 v[232:235], v1, s[20:23], s59 offen offset:2048 sc1
    v_mfma_f32_16x16x32_bf16 v[192:195], v[60:63], v[32:35], v[192:195]
    s_lshl_b32 s3, s77, 13
    s_add_u32 s3, s3, 131072
    v_mfma_f32_16x16x32_bf16 v[196:199], v[60:63], v[36:39], v[196:199]
    v_cvt_pk_bf16_f32 v240, v240, v241
    v_cvt_pk_bf16_f32 v241, v242, v243
    v_mfma_f32_16x16x32_bf16 v[196:199], v[56:59], v[20:23], v[196:199]
    v_cvt_pk_bf16_f32 v242, v244, v245
    v_cvt_pk_bf16_f32 v243, v246, v247
    v_mfma_f32_16x16x32_bf16 v[200:203], v[64:67], v[16:19], v[200:203]
    buffer_store_dwordx4 v[240:243], v1, s[20:23], s59 offen offset:3072 sc1
    v_mfma_f32_16x16x32_bf16 v[200:203], v[68:71], v[32:35], v[200:203]
    v_add_u32 v99, s3, v99
    v_xor_b32 v100, 0, v98
    v_mfma_f32_16x16x32_bf16 v[204:207], v[68:71], v[36:39], v[204:207]
    v_lshl_add_u32 v80, v100, 4, v99
    v_xor_b32 v100, 2, v98
    v_mfma_f32_16x16x32_bf16 v[204:207], v[64:67], v[20:23], v[204:207]
    v_lshl_add_u32 v81, v100, 4, v99
    v_xor_b32 v100, 4, v98
    v_mfma_f32_16x16x32_bf16 v[208:211], v[72:75], v[16:19], v[208:211]
    v_lshl_add_u32 v82, v100, 4, v99
    v_xor_b32 v100, 6, v98
    v_mfma_f32_16x16x32_bf16 v[208:211], v[76:79], v[32:35], v[208:211]
    v_lshl_add_u32 v83, v100, 4, v99
    v_lshrrev_b32 v98, 2, v0
    v_mfma_f32_16x16x32_bf16 v[212:215], v[76:79], v[36:39], v[212:215]
    v_bfe_u32 v99, v0, 3, 2
    s_lshl_b32 s3, s77, 1
    v_mfma_f32_16x16x32_bf16 v[212:215], v[72:75], v[20:23], v[212:215]
    v_and_b32 v100, 2, v0
    v_lshl_or_b32 v100, v100, 1, s3
    v_xor_b32 v99, v99, v100
    v_and_b32 v100, 1, v0
    v_lshlrev_b32 v100, 3, v100
    v_lshl_add_u32 v100, v98, 7, v100
    s_lshl_b32 s3, s0, 13
    s_add_u32 s3, s3, 147456
    v_add_u32 v100, s3, v100
    v_lshl_add_u32 v84, v99, 4, v100
    v_xor_b32 v85, 16, v84
    s_barrier
    ds_read_b64 v[92:93], v101 offset:0
    ds_read_b64 v[94:95], v101 offset:128
    ds_read_b64 v[16:17], v80 offset:0
    ds_read_b64_tr_b16 v[32:33], v84 offset:0
    ds_read_b64 v[18:19], v80 offset:4096
    ds_read_b64_tr_b16 v[34:35], v85 offset:0
    ds_read_b64 v[20:21], v81 offset:0
    ds_read_b64_tr_b16 v[36:37], v84 offset:2048
    ds_read_b64 v[22:23], v81 offset:4096
    ds_read_b64_tr_b16 v[38:39], v85 offset:2048
    ds_read_b64 v[24:25], v82 offset:0
    ds_read_b64_tr_b16 v[40:41], v84 offset:4096
    ds_read_b64 v[26:27], v82 offset:4096
    ds_read_b64_tr_b16 v[42:43], v85 offset:4096
    ds_read_b64 v[28:29], v83 offset:0
    ds_read_b64_tr_b16 v[44:45], v84 offset:6144
    ds_read_b64 v[30:31], v83 offset:4096
    ds_read_b64_tr_b16 v[46:47], v85 offset:6144
    s_mov_b64 s[24:25], s[84:85]
    s_mov_b32 s26, 0x400000
    s_mov_b32 s27, 0x20000
    s_lshl_b32 s1, s2, 3
    s_add_u32 s1, s1, s7
    s_lshl_b32 s1, s1, 7
    s_add_u32 s1, s1, 0x2040000
    s_xor_b32 s62, s1, 1024
    v_lshrrev_b32 v98, 1, v97
    v_and_b32 v99, 7, v96
    v_xor_b32 v98, v98, v99
    v_and_b32 v99, 1, v97
    v_lshlrev_b32 v99, 3, v99
    v_lshl_add_u32 v99, v96, 7, v99
    s_lshl_b32 s3, s7, 12
    v_add_u32 v99, s3, v99
    v_xor_b32 v100, 0, v98
    v_lshl_add_u32 v86, v100, 4, v99
    v_xor_b32 v100, 2, v98
    v_lshl_add_u32 v87, v100, 4, v99
    v_xor_b32 v100, 4, v98
    v_lshl_add_u32 v88, v100, 4, v99
    v_xor_b32 v100, 6, v98
    v_lshl_add_u32 v89, v100, 4, v99
    v_lshrrev_b32 v98, 3, v0
    v_and_b32 v99, 7, v0
    v_xor_b32 v100, v98, v99
    v_lshlrev_b32 v100, 4, v100
    v_lshl_add_u32 v100, v98, 7, v100
    v_add_u32 v90, s3, v100
    v_lshlrev_b32 v99, 4, v99
    v_lshl_add_u32 v91, v98, 11, v99
    s_lshl_b32 s61, s61, 16
    s_lshl_b32 s3, s55, 8
    s_add_u32 s61, s61, s3
    s_lshl_b32 s3, s0, 7
    s_add_u32 s61, s61, s3
    s_waitcnt lgkmcnt(0)
    s_waitcnt vmcnt(0)
    s_mov_b64 exec, 1
    buffer_store_dword v253, v252, s[20:23], s1 offen sc1
    s_mov_b64 exec, -1
    buffer_load_dword v108, v252, s[20:23], s62 offen sc1
    v_lshlrev_b32 v104, 16, v16
    v_and_b32 v105, 0xffff0000, v16
    v_lshlrev_b32 v106, 16, v32
    v_and_b32 v107, 0xffff0000, v32
    v_pk_mul_f32 v[104:105], v[104:105], v[106:107]
    v_pk_mul_f32 v[104:105], v[104:105], v[92:93] op_sel_hi:[1,0]
    v_pk_fma_f32 v[184:185], v[184:185], v[92:93], v[104:105] op_sel:[0,1,0] op_sel_hi:[1,1,1]
    v_lshlrev_b32 v104, 16, v17
    v_and_b32 v105, 0xffff0000, v17
    v_lshlrev_b32 v106, 16, v33
    v_and_b32 v107, 0xffff0000, v33
    v_pk_mul_f32 v[104:105], v[104:105], v[106:107]
    v_pk_mul_f32 v[104:105], v[104:105], v[92:93] op_sel_hi:[1,0]
    v_pk_fma_f32 v[186:187], v[186:187], v[92:93], v[104:105] op_sel:[0,1,0] op_sel_hi:[1,1,1]
    v_lshlrev_b32 v104, 16, v18
    v_and_b32 v105, 0xffff0000, v18
    v_lshlrev_b32 v106, 16, v34
    v_and_b32 v107, 0xffff0000, v34
    v_pk_mul_f32 v[104:105], v[104:105], v[106:107]
    v_pk_mul_f32 v[104:105], v[104:105], v[94:95] op_sel_hi:[1,0]
    v_pk_fma_f32 v[188:189], v[188:189], v[94:95], v[104:105] op_sel:[0,1,0] op_sel_hi:[1,1,1]
    v_lshlrev_b32 v104, 16, v19
    v_and_b32 v105, 0xffff0000, v19
    v_lshlrev_b32 v106, 16, v35
    v_and_b32 v107, 0xffff0000, v35
    v_pk_mul_f32 v[104:105], v[104:105], v[106:107]
    v_pk_mul_f32 v[104:105], v[104:105], v[94:95] op_sel_hi:[1,0]
    v_pk_fma_f32 v[190:191], v[190:191], v[94:95], v[104:105] op_sel:[0,1,0] op_sel_hi:[1,1,1]
    v_lshlrev_b32 v104, 16, v20
    v_and_b32 v105, 0xffff0000, v20
    v_lshlrev_b32 v106, 16, v36
    v_and_b32 v107, 0xffff0000, v36
    v_pk_mul_f32 v[104:105], v[104:105], v[106:107]
    v_pk_mul_f32 v[104:105], v[104:105], v[92:93] op_sel_hi:[1,0]
    v_pk_fma_f32 v[192:193], v[192:193], v[92:93], v[104:105] op_sel:[0,1,0] op_sel_hi:[1,1,1]
    v_lshlrev_b32 v104, 16, v21
    v_and_b32 v105, 0xffff0000, v21
    v_lshlrev_b32 v106, 16, v37
    v_and_b32 v107, 0xffff0000, v37
    v_pk_mul_f32 v[104:105], v[104:105], v[106:107]
    v_pk_mul_f32 v[104:105], v[104:105], v[92:93] op_sel_hi:[1,0]
    v_pk_fma_f32 v[194:195], v[194:195], v[92:93], v[104:105] op_sel:[0,1,0] op_sel_hi:[1,1,1]
    v_lshlrev_b32 v104, 16, v22
    v_and_b32 v105, 0xffff0000, v22
    v_lshlrev_b32 v106, 16, v38
    v_and_b32 v107, 0xffff0000, v38
    v_pk_mul_f32 v[104:105], v[104:105], v[106:107]
    v_pk_mul_f32 v[104:105], v[104:105], v[94:95] op_sel_hi:[1,0]
    v_pk_fma_f32 v[196:197], v[196:197], v[94:95], v[104:105] op_sel:[0,1,0] op_sel_hi:[1,1,1]
    v_lshlrev_b32 v104, 16, v23
    v_and_b32 v105, 0xffff0000, v23
    v_lshlrev_b32 v106, 16, v39
    v_and_b32 v107, 0xffff0000, v39
    v_pk_mul_f32 v[104:105], v[104:105], v[106:107]
    v_pk_mul_f32 v[104:105], v[104:105], v[94:95] op_sel_hi:[1,0]
    v_pk_fma_f32 v[198:199], v[198:199], v[94:95], v[104:105] op_sel:[0,1,0] op_sel_hi:[1,1,1]
    v_lshlrev_b32 v104, 16, v24
    v_and_b32 v105, 0xffff0000, v24
    v_lshlrev_b32 v106, 16, v40
    v_and_b32 v107, 0xffff0000, v40
    v_pk_mul_f32 v[104:105], v[104:105], v[106:107]
    v_pk_mul_f32 v[104:105], v[104:105], v[92:93] op_sel_hi:[1,0]
    v_pk_fma_f32 v[200:201], v[200:201], v[92:93], v[104:105] op_sel:[0,1,0] op_sel_hi:[1,1,1]
    v_lshlrev_b32 v104, 16, v25
    v_and_b32 v105, 0xffff0000, v25
    v_lshlrev_b32 v106, 16, v41
    v_and_b32 v107, 0xffff0000, v41
    v_pk_mul_f32 v[104:105], v[104:105], v[106:107]
    v_pk_mul_f32 v[104:105], v[104:105], v[92:93] op_sel_hi:[1,0]
    v_pk_fma_f32 v[202:203], v[202:203], v[92:93], v[104:105] op_sel:[0,1,0] op_sel_hi:[1,1,1]
    v_lshlrev_b32 v104, 16, v26
    v_and_b32 v105, 0xffff0000, v26
    v_lshlrev_b32 v106, 16, v42
    v_and_b32 v107, 0xffff0000, v42
    v_pk_mul_f32 v[104:105], v[104:105], v[106:107]
    v_pk_mul_f32 v[104:105], v[104:105], v[94:95] op_sel_hi:[1,0]
    v_pk_fma_f32 v[204:205], v[204:205], v[94:95], v[104:105] op_sel:[0,1,0] op_sel_hi:[1,1,1]
    v_lshlrev_b32 v104, 16, v27
    v_and_b32 v105, 0xffff0000, v27
    v_lshlrev_b32 v106, 16, v43
    v_and_b32 v107, 0xffff0000, v43
    v_pk_mul_f32 v[104:105], v[104:105], v[106:107]
    v_pk_mul_f32 v[104:105], v[104:105], v[94:95] op_sel_hi:[1,0]
    v_pk_fma_f32 v[206:207], v[206:207], v[94:95], v[104:105] op_sel:[0,1,0] op_sel_hi:[1,1,1]
    v_lshlrev_b32 v104, 16, v28
    v_and_b32 v105, 0xffff0000, v28
    v_lshlrev_b32 v106, 16, v44
    v_and_b32 v107, 0xffff0000, v44
    v_pk_mul_f32 v[104:105], v[104:105], v[106:107]
    v_pk_mul_f32 v[104:105], v[104:105], v[92:93] op_sel_hi:[1,0]
    v_pk_fma_f32 v[208:209], v[208:209], v[92:93], v[104:105] op_sel:[0,1,0] op_sel_hi:[1,1,1]
    v_lshlrev_b32 v104, 16, v29
    v_and_b32 v105, 0xffff0000, v29
    v_lshlrev_b32 v106, 16, v45
    v_and_b32 v107, 0xffff0000, v45
    v_pk_mul_f32 v[104:105], v[104:105], v[106:107]
    v_pk_mul_f32 v[104:105], v[104:105], v[92:93] op_sel_hi:[1,0]
    v_pk_fma_f32 v[210:211], v[210:211], v[92:93], v[104:105] op_sel:[0,1,0] op_sel_hi:[1,1,1]
    v_lshlrev_b32 v104, 16, v30
    v_and_b32 v105, 0xffff0000, v30
    v_lshlrev_b32 v106, 16, v46
    v_and_b32 v107, 0xffff0000, v46
    v_pk_mul_f32 v[104:105], v[104:105], v[106:107]
    v_pk_mul_f32 v[104:105], v[104:105], v[94:95] op_sel_hi:[1,0]
    v_pk_fma_f32 v[212:213], v[212:213], v[94:95], v[104:105] op_sel:[0,1,0] op_sel_hi:[1,1,1]
    v_lshlrev_b32 v104, 16, v31
    v_and_b32 v105, 0xffff0000, v31
    v_lshlrev_b32 v106, 16, v47
    v_and_b32 v107, 0xffff0000, v47
    v_pk_mul_f32 v[104:105], v[104:105], v[106:107]
    v_pk_mul_f32 v[104:105], v[104:105], v[94:95] op_sel_hi:[1,0]
    v_pk_fma_f32 v[214:215], v[214:215], v[94:95], v[104:105] op_sel:[0,1,0] op_sel_hi:[1,1,1]
    v_lshrrev_b32 v102, 16, v93
    v_lshrrev_b32 v103, 16, v95
    s_mov_b32 s51, 0
L_xchk:
    s_waitcnt vmcnt(0)
    v_readfirstlane_b32 s94, v108
    s_add_u32 s51, s51, 1
    s_cmp_eq_u32 s94, 1
    s_cbranch_scc1 L_xok
    s_cmp_ge_u32 s51, 200000
    s_cbranch_scc1 L_xok
    s_sleep 2
    buffer_load_dword v108, v252, s[20:23], s62 offen sc1
    s_branch L_xchk
L_xok:
    buffer_load_dwordx4 v[64:67], v1, s[20:23], s60 offen offset:0 sc1
    buffer_load_dwordx4 v[68:71], v1, s[20:23], s60 offen offset:1024 sc1
    buffer_load_dwordx4 v[72:75], v1, s[20:23], s60 offen offset:2048 sc1
    buffer_load_dwordx4 v[76:79], v1, s[20:23], s60 offen offset:3072 sc1
    s_waitcnt vmcnt(3)
    v_dot2c_f32_bf16 v184, v64, v102
    v_dot2c_f32_bf16 v185, v64, v93
    v_dot2c_f32_bf16 v186, v65, v102
    v_dot2c_f32_bf16 v187, v65, v93
    v_dot2c_f32_bf16 v188, v66, v103
    v_dot2c_f32_bf16 v189, v66, v95
    v_dot2c_f32_bf16 v190, v67, v103
    v_dot2c_f32_bf16 v191, v67, v95
    v_cvt_pk_bf16_f32 v32, v184, v185
    v_cvt_pk_bf16_f32 v33, v186, v187
    ds_write_b64 v86, v[32:33] offset:0
    v_cvt_pk_bf16_f32 v34, v188, v189
    v_cvt_pk_bf16_f32 v35, v190, v191
    ds_write_b64 v86, v[34:35] offset:2048
    s_waitcnt vmcnt(2)
    v_dot2c_f32_bf16 v192, v68, v102
    v_dot2c_f32_bf16 v193, v68, v93
    v_dot2c_f32_bf16 v194, v69, v102
    v_dot2c_f32_bf16 v195, v69, v93
    v_dot2c_f32_bf16 v196, v70, v103
    v_dot2c_f32_bf16 v197, v70, v95
    v_dot2c_f32_bf16 v198, v71, v103
    v_dot2c_f32_bf16 v199, v71, v95
    v_cvt_pk_bf16_f32 v36, v192, v193
    v_cvt_pk_bf16_f32 v37, v194, v195
    ds_write_b64 v87, v[36:37] offset:0
    v_cvt_pk_bf16_f32 v38, v196, v197
    v_cvt_pk_bf16_f32 v39, v198, v199
    ds_write_b64 v87, v[38:39] offset:2048
    s_waitcnt vmcnt(1)
    v_dot2c_f32_bf16 v200, v72, v102
    v_dot2c_f32_bf16 v201, v72, v93
    v_dot2c_f32_bf16 v202, v73, v102
    v_dot2c_f32_bf16 v203, v73, v93
    v_dot2c_f32_bf16 v204, v74, v103
    v_dot2c_f32_bf16 v205, v74, v95
    v_dot2c_f32_bf16 v206, v75, v103
    v_dot2c_f32_bf16 v207, v75, v95
    v_cvt_pk_bf16_f32 v40, v200, v201
    v_cvt_pk_bf16_f32 v41, v202, v203
    ds_write_b64 v88, v[40:41] offset:0
    v_cvt_pk_bf16_f32 v42, v204, v205
    v_cvt_pk_bf16_f32 v43, v206, v207
    ds_write_b64 v88, v[42:43] offset:2048
    s_waitcnt vmcnt(0)
    v_dot2c_f32_bf16 v208, v76, v102
    v_dot2c_f32_bf16 v209, v76, v93
    v_dot2c_f32_bf16 v210, v77, v102
    v_dot2c_f32_bf16 v211, v77, v93
    v_dot2c_f32_bf16 v212, v78, v103
    v_dot2c_f32_bf16 v213, v78, v95
    v_dot2c_f32_bf16 v214, v79, v103
    v_dot2c_f32_bf16 v215, v79, v95
    v_cvt_pk_bf16_f32 v44, v208, v209
    v_cvt_pk_bf16_f32 v45, v210, v211
    ds_write_b64 v89, v[44:45] offset:0
    v_cvt_pk_bf16_f32 v46, v212, v213
    v_cvt_pk_bf16_f32 v47, v214, v215
    ds_write_b64 v89, v[46:47] offset:2048
    ds_read_b128 v[16:19], v90 offset:0
    ds_read_b128 v[20:23], v90 offset:1024
    ds_read_b128 v[24:27], v90 offset:2048
    ds_read_b128 v[28:31], v90 offset:3072
    s_waitcnt lgkmcnt(3)
    buffer_store_dwordx4 v[16:19], v91, s[24:27], s61 offen nt
    s_add_u32 s61, s61, 0x4000
    s_waitcnt lgkmcnt(2)
    buffer_store_dwordx4 v[20:23], v91, s[24:27], s61 offen nt
    s_add_u32 s61, s61, 0x4000
    s_waitcnt lgkmcnt(1)
    buffer_store_dwordx4 v[24:27], v91, s[24:27], s61 offen nt
    s_add_u32 s61, s61, 0x4000
    s_waitcnt lgkmcnt(0)
    buffer_store_dwordx4 v[28:31], v91, s[24:27], s61 offen nt
    s_add_u32 s61, s61, 0x4000
    s_branch L_fin
L_g1l_event:
    s_cmp_eq_u32 s92, 8
    s_cbranch_scc1 L_g1l_e8
    s_cmp_eq_u32 s92, 12
    s_cbranch_scc1 L_g1l_e12
    s_cmp_eq_u32 s92, 13
    s_cbranch_scc1 L_g1l_e13
    s_mov_b64 s[28:29], s[86:87]
    s_mov_b32 s30, 0x100
    s_mov_b32 s31, 0x20000
    buffer_load_dword v24, v252, s[28:31], 0 offen sc1
L_g1l_eback:
    s_waitcnt vmcnt(13)
    s_branch L_g1l_bar
L_g1l_e8:
    v_readfirstlane_b32 s99, v24
    s_nop 1
    s_cmp_lt_u32 s99, 32
    s_cbranch_scc1 L_g1l_loop
    s_cmp_lg_u32 s4, 4
    s_cbranch_scc1 L_g1l_loop
    s_getreg_b32 s94, hwreg(HW_REG_XCC_ID, 0, 4)
    s_add_u32 s94, s94, 1
    v_mov_b32 v27, s94
    s_lshl_b32 s94, s5, 10
    s_add_u32 s94, s94, 0x2050300
    s_lshl_b32 s3, s6, 2
    s_add_u32 s94, s94, s3
    s_mov_b64 exec, 1
    buffer_store_dword v27, v252, s[20:23], s94 offen
    s_mov_b64 exec, -1
    s_branch L_g1l_eback
L_g1l_e12:
    s_lshl_b32 s94, s5, 10
    s_add_u32 s94, s94, 0x2050300
    buffer_load_dword v25, v20, s[20:23], s94 offen sc1
    s_branch L_g1l_eback
L_g1l_e13:
    s_lshl_b32 s94, s5, 1
    s_lshr_b32 s3, s6, 4
    s_add_u32 s94, s94, s3
    s_lshl_b32 s94, s94, 10
    s_add_u32 s94, s94, 0x2040200
    buffer_load_dword v26, v21, s[20:23], s94 offen sc1
    s_branch L_g1l_eback
L_g1l_late:
    s_add_u32 m0, s58, 32
    s_mov_b32 exec_hi, 3
    ds_write_b128 v216, v[220:223]
    s_mov_b64 exec, -1
    buffer_load_dwordx4 v1, s[40:43], s57 offen offset:0 lds
    buffer_load_dwordx4 v1, s[40:43], s57 offen offset:1024 lds
    buffer_load_dwordx4 v1, s[40:43], s57 offen offset:2048 lds
    buffer_load_dwordx4 v1, s[40:43], s57 offen offset:3072 lds
    s_waitcnt vmcnt(4)
    s_barrier
    s_mov_b64 s[28:29], s[86:87]
    s_mov_b32 s30, 0x100
    s_mov_b32 s31, 0x20000
    v_readfirstlane_b32 s94, v24
    v_mov_b32 v25, 32
    s_nop 0
    s_cmp_ge_u32 s94, 32
    s_cbranch_scc1 L_cntok_1
    s_mov_b32 s51, 0
L_poll_2:
    buffer_load_dword v24, v252, s[28:31], 0 offen sc1
    s_waitcnt vmcnt(0)
    v_cmp_lt_u32 vcc, v24, v25
    s_add_u32 s51, s51, 1
    s_and_b32 s94, vcc_lo, 0x1
    s_cbranch_scc0 L_polldone_3
    s_sleep 32
    s_cmp_lt_u32 s51, 200000
    s_cbranch_scc1 L_poll_2
L_polldone_3:
L_cntok_1:
L_cv_wait:
    s_lshl_b32 s59, s5, 1
    s_lshr_b32 s3, s6, 4
    s_add_u32 s59, s59, s3
    s_lshl_b32 s59, s59, 10
    s_add_u32 s59, s59, 0x2040200
    s_mov_b32 s51, 0
L_poll_4:
    buffer_load_dword v5, v21, s[20:23], s59 offen sc1
    s_waitcnt vmcnt(0)
    v_cmp_ne_u32 vcc, v5, v253
    s_add_u32 s51, s51, 1
    s_and_b32 s94, vcc_lo, 0xffff
    s_cbranch_scc0 L_polldone_5
    s_sleep 6
    s_cmp_lt_u32 s51, 200000
    s_cbranch_scc1 L_poll_4
L_polldone_5:
    s_add_u32 m0, s58, 8320
    s_add_u32 s3, s57, 0x1000000
    buffer_load_dwordx4 v1, s[20:23], s3 offen offset:0 sc1 lds
    buffer_load_dwordx4 v1, s[20:23], s3 offen offset:1024 sc1 lds
    buffer_load_dwordx4 v1, s[20:23], s3 offen offset:2048 sc1 lds
    buffer_load_dwordx4 v1, s[20:23], s3 offen offset:3072 sc1 lds
    s_branch L_conv_l
L_g2l_n0:
    s_mov_b32 s51, 0
L_need_6:
    buffer_load_dword v4, v22, s[20:23], 0 offen sc1
    s_waitcnt vmcnt(0)
    v_cmp_eq_u32 vcc, 1, v4
    s_add_u32 s51, s51, 1
    s_or_b32 s98, vcc_lo, 0xf0000000
    s_bitcmp1_b32 s98, s93
    s_cbranch_scc1 L_g2l_b0
    s_sleep 2
    s_cmp_lt_u32 s51, 200000
    s_cbranch_scc1 L_need_6
    s_branch L_g2l_b0
L_g2l_e0:
    s_cmp_eq_u32 s92, s52
    s_cbranch_scc1 L_g2l_out
    s_branch L_g2l_r0
L_g2l_n1:
    s_mov_b32 s51, 0
L_need_7:
    buffer_load_dword v4, v22, s[20:23], 0 offen sc1
    s_waitcnt vmcnt(0)
    v_cmp_eq_u32 vcc, 1, v4
    s_add_u32 s51, s51, 1
    s_or_b32 s98, vcc_lo, 0xf0000000
    s_bitcmp1_b32 s98, s93
    s_cbranch_scc1 L_g2l_b1
    s_sleep 2
    s_cmp_lt_u32 s51, 200000
    s_cbranch_scc1 L_need_7
    s_branch L_g2l_b1
L_g2l_e1:
    s_cmp_eq_u32 s92, s52
    s_cbranch_scc1 L_g2l_out
    s_branch L_g2l_r1
L_g2l_n2:
    s_mov_b32 s51, 0
L_need_8:
    buffer_load_dword v4, v22, s[20:23], 0 offen sc1
    s_waitcnt vmcnt(0)
    v_cmp_eq_u32 vcc, 1, v4
    s_add_u32 s51, s51, 1
    s_or_b32 s98, vcc_lo, 0xf0000000
    s_bitcmp1_b32 s98, s93
    s_cbranch_scc1 L_g2l_b2
    s_sleep 2
    s_cmp_lt_u32 s51, 200000
    s_cbranch_scc1 L_need_8
    s_branch L_g2l_b2
L_g2l_e2:
    s_cmp_eq_u32 s92, s52
    s_cbranch_scc1 L_g2l_out
    s_cmp_lg_u32 s92, 4
    s_cbranch_scc1 L_g2l_x4
    s_lshl_b32 s3, s2, 8
    s_add_u32 s3, s3, s7
    s_lshl_b32 s3, s3, 2
    s_add_u32 s3, s3, s90
    s_mov_b64 exec, 1
    buffer_store_dword v253, v252, s[20:23], s3 offen sc1
    s_mov_b64 exec, -1
L_g2l_x4:
    s_cmp_lg_u32 s92, 20
    s_cbranch_scc1 L_g2l_x20
    s_mov_b32 s51, 0
L_g2l_ycheck:
    v_and_b32 v9, v5, v6
    v_and_b32 v9, v9, v7
    v_cmp_ne_u32 vcc, 1, v9
    s_add_u32 s51, s51, 1
    s_cmp_eq_u64 vcc, 0
    s_cbranch_scc1 L_g2l_x20
    s_cmp_ge_u32 s51, 200000
    s_cbranch_scc1 L_g2l_x20
    s_sleep 6
    buffer_load_dword v5, v203, s[20:23], s90 offen sc1
    buffer_load_dwordx2 v[6:7], v202, s[20:23], s91 offen sc1
    s_waitcnt vmcnt(0)
    s_branch L_g2l_ycheck
L_g2l_x20:
    s_branch L_g2l_r2
L_g2l_n3:
    s_mov_b32 s51, 0
L_need_9:
    buffer_load_dword v4, v22, s[20:23], 0 offen sc1
    s_waitcnt vmcnt(0)
    v_cmp_eq_u32 vcc, 1, v4
    s_add_u32 s51, s51, 1
    s_or_b32 s98, vcc_lo, 0xf0000000
    s_bitcmp1_b32 s98, s93
    s_cbranch_scc1 L_g2l_b3
    s_sleep 2
    s_cmp_lt_u32 s51, 200000
    s_cbranch_scc1 L_need_9
    s_branch L_g2l_b3
L_g2l_e3:
    s_cmp_eq_u32 s92, s52
    s_cbranch_scc1 L_g2l_out
    s_cmp_lg_u32 s92, 17
    s_cbranch_scc1 L_g2l_x17
    buffer_load_dword v5, v203, s[20:23], s90 offen sc1
    buffer_load_dwordx2 v[6:7], v202, s[20:23], s91 offen sc1
L_g2l_x17:
    s_branch L_g2l_r3
L_g1c_plain:
    s_waitcnt lgkmcnt(6)
    v_mfma_f32_16x16x32_bf16 v[120:123], v[80:83], v[16:19], v[120:123]
    ds_read_b128 v[40:43], v2 offset:6144
    v_mfma_f32_16x16x32_bf16 v[120:123], v[84:87], v[20:23], v[120:123]
    ds_read_b128 v[44:47], v3 offset:6144
    v_mfma_f32_16x16x32_bf16 v[124:127], v[92:95], v[20:23], v[124:127]
    v_mfma_f32_16x16x32_bf16 v[124:127], v[88:91], v[16:19], v[124:127]
    v_mfma_f32_16x16x32_bf16 v[184:187], v[96:99], v[16:19], v[184:187]
    v_mfma_f32_16x16x32_bf16 v[184:187], v[100:103], v[20:23], v[184:187]
    s_waitcnt lgkmcnt(4)
    v_mfma_f32_16x16x32_bf16 v[188:191], v[108:111], v[20:23], v[188:191]
    v_mfma_f32_16x16x32_bf16 v[188:191], v[104:107], v[16:19], v[188:191]
    v_mfma_f32_16x16x32_bf16 v[196:199], v[104:107], v[24:27], v[196:199]
    ds_read_b128 v[16:19], v2 offset:8192
    v_mfma_f32_16x16x32_bf16 v[196:199], v[108:111], v[28:31], v[196:199]
    ds_read_b128 v[20:23], v3 offset:8192
    v_mfma_f32_16x16x32_bf16 v[192:195], v[100:103], v[28:31], v[192:195]
    v_mfma_f32_16x16x32_bf16 v[192:195], v[96:99], v[24:27], v[192:195]
    v_mfma_f32_16x16x32_bf16 v[132:135], v[88:91], v[24:27], v[132:135]
    v_mfma_f32_16x16x32_bf16 v[132:135], v[92:95], v[28:31], v[132:135]
    v_mfma_f32_16x16x32_bf16 v[128:131], v[84:87], v[28:31], v[128:131]
    v_mfma_f32_16x16x32_bf16 v[128:131], v[80:83], v[24:27], v[128:131]
    s_waitcnt lgkmcnt(4)
    v_mfma_f32_16x16x32_bf16 v[136:139], v[80:83], v[32:35], v[136:139]
    ds_read_b128 v[24:27], v2 offset:10240
    v_mfma_f32_16x16x32_bf16 v[136:139], v[84:87], v[36:39], v[136:139]
    ds_read_b128 v[28:31], v3 offset:10240
    v_mfma_f32_16x16x32_bf16 v[140:143], v[92:95], v[36:39], v[140:143]
    v_mfma_f32_16x16x32_bf16 v[140:143], v[88:91], v[32:35], v[140:143]
    v_mfma_f32_16x16x32_bf16 v[200:203], v[96:99], v[32:35], v[200:203]
    v_mfma_f32_16x16x32_bf16 v[200:203], v[100:103], v[36:39], v[200:203]
    v_mfma_f32_16x16x32_bf16 v[204:207], v[108:111], v[36:39], v[204:207]
    v_mfma_f32_16x16x32_bf16 v[204:207], v[104:107], v[32:35], v[204:207]
    s_waitcnt lgkmcnt(4)
    v_mfma_f32_16x16x32_bf16 v[212:215], v[104:107], v[40:43], v[212:215]
    ds_read_b128 v[32:35], v2 offset:12288
    v_mfma_f32_16x16x32_bf16 v[212:215], v[108:111], v[44:47], v[212:215]
    ds_read_b128 v[36:39], v3 offset:12288
    v_mfma_f32_16x16x32_bf16 v[208:211], v[100:103], v[44:47], v[208:211]
    v_mfma_f32_16x16x32_bf16 v[208:211], v[96:99], v[40:43], v[208:211]
    v_mfma_f32_16x16x32_bf16 v[148:151], v[88:91], v[40:43], v[148:151]
    v_cvt_pk_bf16_f32 v120, v120, v121
    v_cvt_pk_bf16_f32 v121, v122, v123
    v_mfma_f32_16x16x32_bf16 v[148:151], v[92:95], v[44:47], v[148:151]
    v_cvt_pk_bf16_f32 v122, v124, v125
    v_cvt_pk_bf16_f32 v123, v126, v127
    v_mfma_f32_16x16x32_bf16 v[144:147], v[84:87], v[44:47], v[144:147]
    v_pk_max_i16 v120, v120, 0
    v_pk_max_i16 v121, v121, 0
    v_mfma_f32_16x16x32_bf16 v[144:147], v[80:83], v[40:43], v[144:147]
    s_waitcnt lgkmcnt(4)
    v_pk_max_i16 v122, v122, 0
    v_pk_max_i16 v123, v123, 0
    v_mfma_f32_16x16x32_bf16 v[152:155], v[80:83], v[16:19], v[152:155]
    ds_read_b128 v[40:43], v2 offset:14336
    v_cvt_pk_bf16_f32 v184, v184, v185
    v_cvt_pk_bf16_f32 v185, v186, v187
    buffer_store_dwordx4 v[120:123], v1, s[20:23], s60 offen offset:0
    v_mfma_f32_16x16x32_bf16 v[152:155], v[84:87], v[20:23], v[152:155]
    ds_read_b128 v[44:47], v3 offset:14336
    v_cvt_pk_bf16_f32 v186, v188, v189
    v_cvt_pk_bf16_f32 v187, v190, v191
    v_mfma_f32_16x16x32_bf16 v[156:159], v[92:95], v[20:23], v[156:159]
    v_pk_max_i16 v184, v184, 0
    v_pk_max_i16 v185, v185, 0
    v_mfma_f32_16x16x32_bf16 v[156:159], v[88:91], v[16:19], v[156:159]
    v_pk_max_i16 v186, v186, 0
    v_pk_max_i16 v187, v187, 0
    v_mfma_f32_16x16x32_bf16 v[216:219], v[96:99], v[16:19], v[216:219]
    v_cvt_pk_bf16_f32 v192, v192, v193
    v_cvt_pk_bf16_f32 v193, v194, v195
    buffer_store_dwordx4 v[184:187], v1, s[20:23], s62 offen offset:0
    v_mfma_f32_16x16x32_bf16 v[216:219], v[100:103], v[20:23], v[216:219]
    v_cvt_pk_bf16_f32 v194, v196, v197
    v_cvt_pk_bf16_f32 v195, v198, v199
    v_mfma_f32_16x16x32_bf16 v[220:223], v[108:111], v[20:23], v[220:223]
    v_pk_max_i16 v192, v192, 0
    v_pk_max_i16 v193, v193, 0
    v_mfma_f32_16x16x32_bf16 v[220:223], v[104:107], v[16:19], v[220:223]
    s_waitcnt lgkmcnt(4)
    v_pk_max_i16 v194, v194, 0
    v_pk_max_i16 v195, v195, 0
    v_mfma_f32_16x16x32_bf16 v[228:231], v[104:107], v[24:27], v[228:231]
    v_cvt_pk_bf16_f32 v128, v128, v129
    v_cvt_pk_bf16_f32 v129, v130, v131
    buffer_store_dwordx4 v[192:195], v1, s[20:23], s62 offen offset:1024
    v_mfma_f32_16x16x32_bf16 v[228:231], v[108:111], v[28:31], v[228:231]
    v_cvt_pk_bf16_f32 v130, v132, v133
    v_cvt_pk_bf16_f32 v131, v134, v135
    v_mfma_f32_16x16x32_bf16 v[224:227], v[100:103], v[28:31], v[224:227]
    v_pk_max_i16 v128, v128, 0
    v_pk_max_i16 v129, v129, 0
    v_mfma_f32_16x16x32_bf16 v[224:227], v[96:99], v[24:27], v[224:227]
    v_pk_max_i16 v130, v130, 0
    v_pk_max_i16 v131, v131, 0
    v_mfma_f32_16x16x32_bf16 v[164:167], v[88:91], v[24:27], v[164:167]
    v_cvt_pk_bf16_f32 v136, v136, v137
    v_cvt_pk_bf16_f32 v137, v138, v139
    buffer_store_dwordx4 v[128:131], v1, s[20:23], s60 offen offset:1024
    v_mfma_f32_16x16x32_bf16 v[164:167], v[92:95], v[28:31], v[164:167]
    v_cvt_pk_bf16_f32 v138, v140, v141
    v_cvt_pk_bf16_f32 v139, v142, v143
    v_mfma_f32_16x16x32_bf16 v[160:163], v[84:87], v[28:31], v[160:163]
    v_pk_max_i16 v136, v136, 0
    v_pk_max_i16 v137, v137, 0
    v_mfma_f32_16x16x32_bf16 v[160:163], v[80:83], v[24:27], v[160:163]
    s_waitcnt lgkmcnt(0)
    v_pk_max_i16 v138, v138, 0
    v_pk_max_i16 v139, v139, 0
    v_mfma_f32_16x16x32_bf16 v[168:171], v[80:83], v[32:35], v[168:171]
    v_cvt_pk_bf16_f32 v200, v200, v201
    v_cvt_pk_bf16_f32 v201, v202, v203
    buffer_store_dwordx4 v[136:139], v1, s[20:23], s60 offen offset:2048
    v_mfma_f32_16x16x32_bf16 v[168:171], v[84:87], v[36:39], v[168:171]
    v_cvt_pk_bf16_f32 v202, v204, v205
    v_cvt_pk_bf16_f32 v203, v206, v207
    v_mfma_f32_16x16x32_bf16 v[172:175], v[92:95], v[36:39], v[172:175]
    v_pk_max_i16 v200, v200, 0
    v_pk_max_i16 v201, v201, 0
    v_mfma_f32_16x16x32_bf16 v[172:175], v[88:91], v[32:35], v[172:175]
    v_pk_max_i16 v202, v202, 0
    v_pk_max_i16 v203, v203, 0
    v_mfma_f32_16x16x32_bf16 v[232:235], v[96:99], v[32:35], v[232:235]
    v_cvt_pk_bf16_f32 v208, v208, v209
    v_cvt_pk_bf16_f32 v209, v210, v211
    buffer_store_dwordx4 v[200:203], v1, s[20:23], s62 offen offset:2048
    v_mfma_f32_16x16x32_bf16 v[232:235], v[100:103], v[36:39], v[232:235]
    v_cvt_pk_bf16_f32 v210, v212, v213
    v_cvt_pk_bf16_f32 v211, v214, v215
    v_mfma_f32_16x16x32_bf16 v[236:239], v[108:111], v[36:39], v[236:239]
    v_pk_max_i16 v208, v208, 0
    v_pk_max_i16 v209, v209, 0
    v_mfma_f32_16x16x32_bf16 v[236:239], v[104:107], v[32:35], v[236:239]
    v_pk_max_i16 v210, v210, 0
    v_pk_max_i16 v211, v211, 0
    v_mfma_f32_16x16x32_bf16 v[244:247], v[104:107], v[40:43], v[244:247]
    v_cvt_pk_bf16_f32 v144, v144, v145
    v_cvt_pk_bf16_f32 v145, v146, v147
    buffer_store_dwordx4 v[208:211], v1, s[20:23], s62 offen offset:3072
    v_mfma_f32_16x16x32_bf16 v[244:247], v[108:111], v[44:47], v[244:247]
    v_cvt_pk_bf16_f32 v146, v148, v149
    v_cvt_pk_bf16_f32 v147, v150, v151
    v_mfma_f32_16x16x32_bf16 v[240:243], v[100:103], v[44:47], v[240:243]
    v_pk_max_i16 v144, v144, 0
    v_pk_max_i16 v145, v145, 0
    v_mfma_f32_16x16x32_bf16 v[240:243], v[96:99], v[40:43], v[240:243]
    v_pk_max_i16 v146, v146, 0
    v_pk_max_i16 v147, v147, 0
    v_mfma_f32_16x16x32_bf16 v[180:183], v[88:91], v[40:43], v[180:183]
    v_cvt_pk_bf16_f32 v152, v152, v153
    v_cvt_pk_bf16_f32 v153, v154, v155
    buffer_store_dwordx4 v[144:147], v1, s[20:23], s60 offen offset:3072
    v_mfma_f32_16x16x32_bf16 v[180:183], v[92:95], v[44:47], v[180:183]
    v_cvt_pk_bf16_f32 v154, v156, v157
    v_cvt_pk_bf16_f32 v155, v158, v159
    v_mfma_f32_16x16x32_bf16 v[176:179], v[84:87], v[44:47], v[176:179]
    v_pk_max_i16 v152, v152, 0
    v_pk_max_i16 v153, v153, 0
    v_mfma_f32_16x16x32_bf16 v[176:179], v[80:83], v[40:43], v[176:179]
    v_pk_max_i16 v154, v154, 0
    v_pk_max_i16 v155, v155, 0
    buffer_store_dwordx4 v[152:155], v1, s[20:23], s61 offen offset:0
    v_cvt_pk_bf16_f32 v216, v216, v217
    v_cvt_pk_bf16_f32 v217, v218, v219
    v_cvt_pk_bf16_f32 v218, v220, v221
    v_cvt_pk_bf16_f32 v219, v222, v223
    v_pk_max_i16 v216, v216, 0
    v_pk_max_i16 v217, v217, 0
    v_pk_max_i16 v218, v218, 0
    v_pk_max_i16 v219, v219, 0
    buffer_store_dwordx4 v[216:219], v1, s[20:23], s63 offen offset:0
    v_cvt_pk_bf16_f32 v224, v224, v225
    v_cvt_pk_bf16_f32 v225, v226, v227
    v_cvt_pk_bf16_f32 v226, v228, v229
    v_cvt_pk_bf16_f32 v227, v230, v231
    v_pk_max_i16 v224, v224, 0
    v_pk_max_i16 v225, v225, 0
    v_pk_max_i16 v226, v226, 0
    v_pk_max_i16 v227, v227, 0
    buffer_store_dwordx4 v[224:227], v1, s[20:23], s63 offen offset:1024
    v_cvt_pk_bf16_f32 v160, v160, v161
    v_cvt_pk_bf16_f32 v161, v162, v163
    v_cvt_pk_bf16_f32 v162, v164, v165
    v_cvt_pk_bf16_f32 v163, v166, v167
    v_pk_max_i16 v160, v160, 0
    v_pk_max_i16 v161, v161, 0
    v_pk_max_i16 v162, v162, 0
    v_pk_max_i16 v163, v163, 0
    buffer_store_dwordx4 v[160:163], v1, s[20:23], s61 offen offset:1024
    v_cvt_pk_bf16_f32 v168, v168, v169
    v_cvt_pk_bf16_f32 v169, v170, v171
    v_cvt_pk_bf16_f32 v170, v172, v173
    v_cvt_pk_bf16_f32 v171, v174, v175
    v_pk_max_i16 v168, v168, 0
    v_pk_max_i16 v169, v169, 0
    v_pk_max_i16 v170, v170, 0
    v_pk_max_i16 v171, v171, 0
    buffer_store_dwordx4 v[168:171], v1, s[20:23], s61 offen offset:2048
    v_cvt_pk_bf16_f32 v232, v232, v233
    v_cvt_pk_bf16_f32 v233, v234, v235
    v_cvt_pk_bf16_f32 v234, v236, v237
    v_cvt_pk_bf16_f32 v235, v238, v239
    v_pk_max_i16 v232, v232, 0
    v_pk_max_i16 v233, v233, 0
    v_pk_max_i16 v234, v234, 0
    v_pk_max_i16 v235, v235, 0
    buffer_store_dwordx4 v[232:235], v1, s[20:23], s63 offen offset:2048
    v_cvt_pk_bf16_f32 v240, v240, v241
    v_cvt_pk_bf16_f32 v241, v242, v243
    v_cvt_pk_bf16_f32 v242, v244, v245
    v_cvt_pk_bf16_f32 v243, v246, v247
    v_pk_max_i16 v240, v240, 0
    v_pk_max_i16 v241, v241, 0
    v_pk_max_i16 v242, v242, 0
    v_pk_max_i16 v243, v243, 0
    buffer_store_dwordx4 v[240:243], v1, s[20:23], s63 offen offset:3072
    v_cvt_pk_bf16_f32 v176, v176, v177
    v_cvt_pk_bf16_f32 v177, v178, v179
    v_cvt_pk_bf16_f32 v178, v180, v181
    v_cvt_pk_bf16_f32 v179, v182, v183
    v_pk_max_i16 v176, v176, 0
    v_pk_max_i16 v177, v177, 0
    v_pk_max_i16 v178, v178, 0
    v_pk_max_i16 v179, v179, 0
    buffer_store_dwordx4 v[176:179], v1, s[20:23], s61 offen offset:3072
    s_branch L_g1c_join
L_warm_end:
L_g1c_slow:
    s_mov_b64 s[28:29], s[86:87]
    s_mov_b32 s30, 0x100
    s_mov_b32 s31, 0x20000
    buffer_load_dword v16, v252, s[28:31], 0 offen sc1
    s_waitcnt vmcnt(0)
    v_readfirstlane_b32 s94, v16
    v_mov_b32 v17, 32
    s_nop 0
    s_cmp_ge_u32 s94, 32
    s_cbranch_scc1 L_cntok_10
    s_mov_b32 s51, 0
L_poll_11:
    buffer_load_dword v16, v252, s[28:31], 0 offen sc1
    s_waitcnt vmcnt(0)
    v_cmp_lt_u32 vcc, v16, v17
    s_add_u32 s51, s51, 1
    s_and_b32 s94, vcc_lo, 0x1
    s_cbranch_scc0 L_polldone_12
    s_sleep 32
    s_cmp_lt_u32 s51, 200000
    s_cbranch_scc1 L_poll_11
L_polldone_12:
L_cntok_10:
    s_mov_b64 exec, 1
    buffer_store_dword v253, v252, s[20:23], s1 offen sc1
    s_mov_b64 exec, -1
    s_branch L_g2_c
L_prep:
    v_mov_b32 v252, 0
    v_mov_b32 v253, 1
    s_waitcnt lgkmcnt(0)
    s_mov_b64 s[8:9], s[64:65]
    s_mov_b32 s10, 0x400000
    s_mov_b32 s11, 0x20000
    s_mov_b64 s[20:21], s[88:89]
    s_mov_b32 s22, 0x10000000
    s_mov_b32 s23, 0x20000
    s_mov_b64 s[32:33], s[66:67]
    s_mov_b32 s34, 0x400000
    s_mov_b32 s35, 0x20000
    s_mov_b64 s[36:37], s[68:69]
    s_mov_b32 s38, 0x400000
    s_mov_b32 s39, 0x20000
    s_mov_b64 s[48:49], s[70:71]
    s_mov_b32 s50, 0x2000
    s_mov_b32 s51, 0x20000
    s_lshr_b32 s57, s2, 6
    s_lshl2_add_u32 s57, s5, s57
    s_cmp_lg_u32 s4, 0
    s_cbranch_scc1 L_prep_noreset
    s_mov_b64 s[28:29], s[86:87]
    s_mov_b32 s30, 0x100
    s_mov_b32 s31, 0x20000
    s_lshl_b32 s58, s57, 13
    s_add_u32 s58, s58, 0x2040000
    s_add_u32 s59, s58, 0x1000
    v_lshlrev_b32 v2, 4, v0
    v_mov_b32 v8, 0
    v_mov_b32 v9, 0
    v_mov_b32 v10, 0
    v_mov_b32 v11, 0
    buffer_store_dwordx4 v[8:11], v2, s[20:23], s58 offen offset:0 sc1
    buffer_store_dwordx4 v[8:11], v2, s[20:23], s58 offen offset:1024 sc1
    buffer_store_dwordx4 v[8:11], v2, s[20:23], s58 offen offset:2048 sc1
    buffer_store_dwordx4 v[8:11], v2, s[20:23], s58 offen offset:3072 sc1
    buffer_store_dwordx4 v[8:11], v2, s[20:23], s59 offen offset:0 sc1
    buffer_store_dwordx4 v[8:11], v2, s[20:23], s59 offen offset:1024 sc1
    buffer_store_dwordx4 v[8:11], v2, s[20:23], s59 offen offset:2048 sc1
    buffer_store_dwordx4 v[8:11], v2, s[20:23], s59 offen offset:3072 sc1
    s_waitcnt vmcnt(0)
    s_mov_b64 exec, 1
    buffer_atomic_add v253, v252, s[28:31], 0 offen sc1
    s_mov_b64 exec, -1
L_prep_noreset:
    s_lshr_b32 s58, s57, 1
    s_and_b32 s57, s57, 1
    s_lshl_b32 s57, s57, 3
    s_add_u32 s57, s57, s4
    s_lshl_b32 s59, s58, 18
    s_lshl_b32 s60, s57, 7
    s_add_u32 s59, s59, s60
    v_lshrrev_b32 v1, 3, v0
    v_lshlrev_b32 v1, 15, v1
    v_and_b32 v2, 7, v0
    v_lshl_add_u32 v1, v2, 4, v1
    v_add_u32 v1, s59, v1
    v_subrev_u32 v3, 6144, v1
    v_lshlrev_b32 v2, 6, v2
    s_lshl_b32 s60, s57, 9
    buffer_load_dwordx4 v[208:211], v2, s[48:51], s60 offen offset:0
    buffer_load_dwordx4 v[212:215], v2, s[48:51], s60 offen offset:16
    buffer_load_dwordx4 v[216:219], v2, s[48:51], s60 offen offset:32
    buffer_load_dwordx4 v[220:223], v2, s[48:51], s60 offen offset:48
    buffer_load_dwordx4 v[4:7], v3, s[32:35], 0 offen
    buffer_load_dwordx4 v[8:11], v3, s[32:35], 0 offen offset:2048
    s_movk_i32 s61, 0x1000
    buffer_load_dwordx4 v[12:15], v3, s[32:35], s61 offen
    s_movk_i32 s62, 0x0
    buffer_load_dwordx4 v[16:19], v1, s[32:35], s62 offen offset:0
    buffer_load_dwordx4 v[80:83], v1, s[36:39], s62 offen offset:0
    buffer_load_dwordx4 v[20:23], v1, s[32:35], s62 offen offset:2048
    buffer_load_dwordx4 v[84:87], v1, s[36:39], s62 offen offset:2048
    s_movk_i32 s62, 0x1000
    buffer_load_dwordx4 v[24:27], v1, s[32:35], s62 offen offset:0
    buffer_load_dwordx4 v[88:91], v1, s[36:39], s62 offen offset:0
    s_lshl_b32 s61, s4, 14
    s_add_u32 s61, s61, 0x8000
    v_and_b32 v2, 7, v0
    v_lshrrev_b32 v3, 3, v0
    v_lshlrev_b32 v3, 1, v3
    v_sub_u32 v3, 15, v3
    v_xor_b32 v3, v3, v2
    v_lshlrev_b32 v3, 4, v3
    v_lshl_add_u32 v3, v2, 11, v3
    v_add_u32 v2, s61, v3
    v_xor_b32 v3, 16, v2
    s_setprio 1
    s_waitcnt vmcnt(9)
    v_lshlrev_b32 v144, 16, v208
    v_and_b32 v152, 0xffff0000, v208
    v_lshlrev_b32 v160, 16, v209
    v_and_b32 v168, 0xffff0000, v209
    v_lshlrev_b32 v145, 16, v210
    v_and_b32 v153, 0xffff0000, v210
    v_lshlrev_b32 v161, 16, v211
    v_and_b32 v169, 0xffff0000, v211
    v_lshlrev_b32 v146, 16, v212
    v_and_b32 v154, 0xffff0000, v212
    v_lshlrev_b32 v162, 16, v213
    v_and_b32 v170, 0xffff0000, v213
    v_lshlrev_b32 v147, 16, v214
    v_and_b32 v155, 0xffff0000, v214
    v_lshlrev_b32 v163, 16, v215
    v_and_b32 v171, 0xffff0000, v215
    v_lshlrev_b32 v148, 16, v216
    v_and_b32 v156, 0xffff0000, v216
    v_lshlrev_b32 v164, 16, v217
    v_and_b32 v172, 0xffff0000, v217
    v_lshlrev_b32 v149, 16, v218
    v_and_b32 v157, 0xffff0000, v218
    v_lshlrev_b32 v165, 16, v219
    v_and_b32 v173, 0xffff0000, v219
    v_lshlrev_b32 v150, 16, v220
    v_and_b32 v158, 0xffff0000, v220
    v_lshlrev_b32 v166, 16, v221
    v_and_b32 v174, 0xffff0000, v221
    v_lshlrev_b32 v151, 16, v222
    v_and_b32 v159, 0xffff0000, v222
    v_lshlrev_b32 v167, 16, v223
    v_and_b32 v175, 0xffff0000, v223
    s_waitcnt vmcnt(6)
    v_lshlrev_b32 v176, 16, v4
    v_and_b32 v177, 0xffff0000, v4
    v_lshlrev_b32 v178, 16, v5
    v_and_b32 v179, 0xffff0000, v5
    v_lshlrev_b32 v180, 16, v6
    v_and_b32 v181, 0xffff0000, v6
    v_lshlrev_b32 v182, 16, v7
    v_and_b32 v183, 0xffff0000, v7
    v_lshlrev_b32 v184, 16, v8
    v_and_b32 v185, 0xffff0000, v8
    v_lshlrev_b32 v186, 16, v9
    v_and_b32 v187, 0xffff0000, v9
    v_lshlrev_b32 v188, 16, v10
    v_and_b32 v189, 0xffff0000, v10
    v_lshlrev_b32 v190, 16, v11
    v_and_b32 v191, 0xffff0000, v11
    v_lshlrev_b32 v192, 16, v12
    v_and_b32 v193, 0xffff0000, v12
    v_lshlrev_b32 v194, 16, v13
    v_and_b32 v195, 0xffff0000, v13
    v_lshlrev_b32 v196, 16, v14
    v_and_b32 v197, 0xffff0000, v14
    v_lshlrev_b32 v198, 16, v15
    v_and_b32 v199, 0xffff0000, v15
    s_waitcnt vmcnt(4)
    v_lshlrev_b32 v200, 16, v16
    v_and_b32 v201, 0xffff0000, v16
    v_lshlrev_b32 v202, 16, v17
    v_and_b32 v203, 0xffff0000, v17
    v_lshlrev_b32 v204, 16, v18
    v_and_b32 v205, 0xffff0000, v18
    v_lshlrev_b32 v206, 16, v19
    v_and_b32 v207, 0xffff0000, v19
    v_lshlrev_b32 v208, 16, v80
    v_and_b32 v209, 0xffff0000, v80
    v_lshlrev_b32 v210, 16, v81
    v_and_b32 v211, 0xffff0000, v81
    v_lshlrev_b32 v212, 16, v82
    v_and_b32 v213, 0xffff0000, v82
    v_lshlrev_b32 v214, 16, v83
    v_and_b32 v215, 0xffff0000, v83
    v_pk_mul_f32 v[4:5], v[176:177], v[168:169]
    v_pk_mul_f32 v[6:7], v[178:179], v[170:171]
    v_pk_mul_f32 v[8:9], v[180:181], v[172:173]
    v_pk_mul_f32 v[10:11], v[182:183], v[174:175]
    v_pk_fma_f32 v[4:5], v[184:185], v[160:161], v[4:5]
    v_pk_fma_f32 v[6:7], v[186:187], v[162:163], v[6:7]
    v_pk_fma_f32 v[8:9], v[188:189], v[164:165], v[8:9]
    v_pk_fma_f32 v[10:11], v[190:191], v[166:167], v[10:11]
    v_pk_fma_f32 v[4:5], v[192:193], v[152:153], v[4:5]
    v_pk_fma_f32 v[6:7], v[194:195], v[154:155], v[6:7]
    v_pk_fma_f32 v[8:9], v[196:197], v[156:157], v[8:9]
    v_pk_fma_f32 v[10:11], v[198:199], v[158:159], v[10:11]
    v_pk_fma_f32 v[4:5], v[200:201], v[144:145], v[4:5]
    v_pk_fma_f32 v[6:7], v[202:203], v[146:147], v[6:7]
    v_pk_fma_f32 v[8:9], v[204:205], v[148:149], v[8:9]
    v_pk_fma_f32 v[10:11], v[206:207], v[150:151], v[10:11]
    v_pk_mul_f32 v[208:209], v[208:209], v[4:5]
    v_pk_mul_f32 v[210:211], v[210:211], v[6:7]
    v_pk_mul_f32 v[212:213], v[212:213], v[8:9]
    v_pk_mul_f32 v[214:215], v[214:215], v[10:11]
    buffer_load_dwordx4 v[28:31], v1, s[32:35], s62 offen offset:2048
    buffer_load_dwordx4 v[92:95], v1, s[36:39], s62 offen offset:2048
    s_waitcnt vmcnt(4)
    v_lshlrev_b32 v176, 16, v20
    v_and_b32 v177, 0xffff0000, v20
    v_lshlrev_b32 v178, 16, v21
    v_and_b32 v179, 0xffff0000, v21
    v_lshlrev_b32 v180, 16, v22
    v_and_b32 v181, 0xffff0000, v22
    v_lshlrev_b32 v182, 16, v23
    v_and_b32 v183, 0xffff0000, v23
    v_lshlrev_b32 v216, 16, v84
    v_and_b32 v217, 0xffff0000, v84
    v_lshlrev_b32 v218, 16, v85
    v_and_b32 v219, 0xffff0000, v85
    v_lshlrev_b32 v220, 16, v86
    v_and_b32 v221, 0xffff0000, v86
    v_lshlrev_b32 v222, 16, v87
    v_and_b32 v223, 0xffff0000, v87
    v_pk_mul_f32 v[4:5], v[184:185], v[168:169]
    v_pk_mul_f32 v[6:7], v[186:187], v[170:171]
    v_pk_mul_f32 v[8:9], v[188:189], v[172:173]
    v_pk_mul_f32 v[10:11], v[190:191], v[174:175]
    v_pk_fma_f32 v[4:5], v[192:193], v[160:161], v[4:5]
    v_pk_fma_f32 v[6:7], v[194:195], v[162:163], v[6:7]
    v_pk_fma_f32 v[8:9], v[196:197], v[164:165], v[8:9]
    v_pk_fma_f32 v[10:11], v[198:199], v[166:167], v[10:11]
    v_pk_fma_f32 v[4:5], v[200:201], v[152:153], v[4:5]
    v_pk_fma_f32 v[6:7], v[202:203], v[154:155], v[6:7]
    v_pk_fma_f32 v[8:9], v[204:205], v[156:157], v[8:9]
    v_pk_fma_f32 v[10:11], v[206:207], v[158:159], v[10:11]
    v_pk_fma_f32 v[4:5], v[176:177], v[144:145], v[4:5]
    v_pk_fma_f32 v[6:7], v[178:179], v[146:147], v[6:7]
    v_pk_fma_f32 v[8:9], v[180:181], v[148:149], v[8:9]
    v_pk_fma_f32 v[10:11], v[182:183], v[150:151], v[10:11]
    v_pk_mul_f32 v[216:217], v[216:217], v[4:5]
    v_pk_mul_f32 v[218:219], v[218:219], v[6:7]
    v_pk_mul_f32 v[220:221], v[220:221], v[8:9]
    v_pk_mul_f32 v[222:223], v[222:223], v[10:11]
    v_cvt_pk_bf16_f32 v227, v216, v208
    v_cvt_pk_bf16_f32 v231, v217, v209
    v_cvt_pk_bf16_f32 v235, v218, v210
    v_cvt_pk_bf16_f32 v239, v219, v211
    v_cvt_pk_bf16_f32 v243, v220, v212
    v_cvt_pk_bf16_f32 v247, v221, v213
    v_cvt_pk_bf16_f32 v15, v222, v214
    v_cvt_pk_bf16_f32 v19, v223, v215
    s_movk_i32 s62, 0x2000
    buffer_load_dwordx4 v[32:35], v1, s[32:35], s62 offen offset:0
    buffer_load_dwordx4 v[96:99], v1, s[36:39], s62 offen offset:0
    s_waitcnt vmcnt(4)
    v_lshlrev_b32 v184, 16, v24
    v_and_b32 v185, 0xffff0000, v24
    v_lshlrev_b32 v186, 16, v25
    v_and_b32 v187, 0xffff0000, v25
    v_lshlrev_b32 v188, 16, v26
    v_and_b32 v189, 0xffff0000, v26
    v_lshlrev_b32 v190, 16, v27
    v_and_b32 v191, 0xffff0000, v27
    v_lshlrev_b32 v208, 16, v88
    v_and_b32 v209, 0xffff0000, v88
    v_lshlrev_b32 v210, 16, v89
    v_and_b32 v211, 0xffff0000, v89
    v_lshlrev_b32 v212, 16, v90
    v_and_b32 v213, 0xffff0000, v90
    v_lshlrev_b32 v214, 16, v91
    v_and_b32 v215, 0xffff0000, v91
    v_pk_mul_f32 v[4:5], v[192:193], v[168:169]
    v_pk_mul_f32 v[6:7], v[194:195], v[170:171]
    v_pk_mul_f32 v[8:9], v[196:197], v[172:173]
    v_pk_mul_f32 v[10:11], v[198:199], v[174:175]
    v_pk_fma_f32 v[4:5], v[200:201], v[160:161], v[4:5]
    v_pk_fma_f32 v[6:7], v[202:203], v[162:163], v[6:7]
    v_pk_fma_f32 v[8:9], v[204:205], v[164:165], v[8:9]
    v_pk_fma_f32 v[10:11], v[206:207], v[166:167], v[10:11]
    v_pk_fma_f32 v[4:5], v[176:177], v[152:153], v[4:5]
    v_pk_fma_f32 v[6:7], v[178:179], v[154:155], v[6:7]
    v_pk_fma_f32 v[8:9], v[180:181], v[156:157], v[8:9]
    v_pk_fma_f32 v[10:11], v[182:183], v[158:159], v[10:11]
    v_pk_fma_f32 v[4:5], v[184:185], v[144:145], v[4:5]
    v_pk_fma_f32 v[6:7], v[186:187], v[146:147], v[6:7]
    v_pk_fma_f32 v[8:9], v[188:189], v[148:149], v[8:9]
    v_pk_fma_f32 v[10:11], v[190:191], v[150:151], v[10:11]
    v_pk_mul_f32 v[208:209], v[208:209], v[4:5]
    v_pk_mul_f32 v[210:211], v[210:211], v[6:7]
    v_pk_mul_f32 v[212:213], v[212:213], v[8:9]
    v_pk_mul_f32 v[214:215], v[214:215], v[10:11]
    buffer_load_dwordx4 v[36:39], v1, s[32:35], s62 offen offset:2048
    buffer_load_dwordx4 v[100:103], v1, s[36:39], s62 offen offset:2048
    s_waitcnt vmcnt(4)
    v_lshlrev_b32 v192, 16, v28
    v_and_b32 v193, 0xffff0000, v28
    v_lshlrev_b32 v194, 16, v29
    v_and_b32 v195, 0xffff0000, v29
    v_lshlrev_b32 v196, 16, v30
    v_and_b32 v197, 0xffff0000, v30
    v_lshlrev_b32 v198, 16, v31
    v_and_b32 v199, 0xffff0000, v31
    v_lshlrev_b32 v216, 16, v92
    v_and_b32 v217, 0xffff0000, v92
    v_lshlrev_b32 v218, 16, v93
    v_and_b32 v219, 0xffff0000, v93
    v_lshlrev_b32 v220, 16, v94
    v_and_b32 v221, 0xffff0000, v94
    v_lshlrev_b32 v222, 16, v95
    v_and_b32 v223, 0xffff0000, v95
    v_pk_mul_f32 v[4:5], v[200:201], v[168:169]
    v_pk_mul_f32 v[6:7], v[202:203], v[170:171]
    v_pk_mul_f32 v[8:9], v[204:205], v[172:173]
    v_pk_mul_f32 v[10:11], v[206:207], v[174:175]
    v_pk_fma_f32 v[4:5], v[176:177], v[160:161], v[4:5]
    v_pk_fma_f32 v[6:7], v[178:179], v[162:163], v[6:7]
    v_pk_fma_f32 v[8:9], v[180:181], v[164:165], v[8:9]
    v_pk_fma_f32 v[10:11], v[182:183], v[166:167], v[10:11]
    v_pk_fma_f32 v[4:5], v[184:185], v[152:153], v[4:5]
    v_pk_fma_f32 v[6:7], v[186:187], v[154:155], v[6:7]
    v_pk_fma_f32 v[8:9], v[188:189], v[156:157], v[8:9]
    v_pk_fma_f32 v[10:11], v[190:191], v[158:159], v[10:11]
    v_pk_fma_f32 v[4:5], v[192:193], v[144:145], v[4:5]
    v_pk_fma_f32 v[6:7], v[194:195], v[146:147], v[6:7]
    v_pk_fma_f32 v[8:9], v[196:197], v[148:149], v[8:9]
    v_pk_fma_f32 v[10:11], v[198:199], v[150:151], v[10:11]
    v_pk_mul_f32 v[216:217], v[216:217], v[4:5]
    v_pk_mul_f32 v[218:219], v[218:219], v[6:7]
    v_pk_mul_f32 v[220:221], v[220:221], v[8:9]
    v_pk_mul_f32 v[222:223], v[222:223], v[10:11]
    v_cvt_pk_bf16_f32 v226, v216, v208
    v_cvt_pk_bf16_f32 v230, v217, v209
    v_cvt_pk_bf16_f32 v234, v218, v210
    v_cvt_pk_bf16_f32 v238, v219, v211
    v_cvt_pk_bf16_f32 v242, v220, v212
    v_cvt_pk_bf16_f32 v246, v221, v213
    v_cvt_pk_bf16_f32 v14, v222, v214
    v_cvt_pk_bf16_f32 v18, v223, v215
    s_movk_i32 s62, 0x3000
    buffer_load_dwordx4 v[40:43], v1, s[32:35], s62 offen offset:0
    buffer_load_dwordx4 v[104:107], v1, s[36:39], s62 offen offset:0
    s_waitcnt vmcnt(4)
    v_lshlrev_b32 v200, 16, v32
    v_and_b32 v201, 0xffff0000, v32
    v_lshlrev_b32 v202, 16, v33
    v_and_b32 v203, 0xffff0000, v33
    v_lshlrev_b32 v204, 16, v34
    v_and_b32 v205, 0xffff0000, v34
    v_lshlrev_b32 v206, 16, v35
    v_and_b32 v207, 0xffff0000, v35
    v_lshlrev_b32 v208, 16, v96
    v_and_b32 v209, 0xffff0000, v96
    v_lshlrev_b32 v210, 16, v97
    v_and_b32 v211, 0xffff0000, v97
    v_lshlrev_b32 v212, 16, v98
    v_and_b32 v213, 0xffff0000, v98
    v_lshlrev_b32 v214, 16, v99
    v_and_b32 v215, 0xffff0000, v99
    v_pk_mul_f32 v[4:5], v[176:177], v[168:169]
    v_pk_mul_f32 v[6:7], v[178:179], v[170:171]
    v_pk_mul_f32 v[8:9], v[180:181], v[172:173]
    v_pk_mul_f32 v[10:11], v[182:183], v[174:175]
    v_pk_fma_f32 v[4:5], v[184:185], v[160:161], v[4:5]
    v_pk_fma_f32 v[6:7], v[186:187], v[162:163], v[6:7]
    v_pk_fma_f32 v[8:9], v[188:189], v[164:165], v[8:9]
    v_pk_fma_f32 v[10:11], v[190:191], v[166:167], v[10:11]
    v_pk_fma_f32 v[4:5], v[192:193], v[152:153], v[4:5]
    v_pk_fma_f32 v[6:7], v[194:195], v[154:155], v[6:7]
    v_pk_fma_f32 v[8:9], v[196:197], v[156:157], v[8:9]
    v_pk_fma_f32 v[10:11], v[198:199], v[158:159], v[10:11]
    v_pk_fma_f32 v[4:5], v[200:201], v[144:145], v[4:5]
    v_pk_fma_f32 v[6:7], v[202:203], v[146:147], v[6:7]
    v_pk_fma_f32 v[8:9], v[204:205], v[148:149], v[8:9]
    v_pk_fma_f32 v[10:11], v[206:207], v[150:151], v[10:11]
    v_pk_mul_f32 v[208:209], v[208:209], v[4:5]
    v_pk_mul_f32 v[210:211], v[210:211], v[6:7]
    v_pk_mul_f32 v[212:213], v[212:213], v[8:9]
    v_pk_mul_f32 v[214:215], v[214:215], v[10:11]
    buffer_load_dwordx4 v[44:47], v1, s[32:35], s62 offen offset:2048
    buffer_load_dwordx4 v[108:111], v1, s[36:39], s62 offen offset:2048
    s_waitcnt vmcnt(4)
    v_lshlrev_b32 v176, 16, v36
    v_and_b32 v177, 0xffff0000, v36
    v_lshlrev_b32 v178, 16, v37
    v_and_b32 v179, 0xffff0000, v37
    v_lshlrev_b32 v180, 16, v38
    v_and_b32 v181, 0xffff0000, v38
    v_lshlrev_b32 v182, 16, v39
    v_and_b32 v183, 0xffff0000, v39
    v_lshlrev_b32 v216, 16, v100
    v_and_b32 v217, 0xffff0000, v100
    v_lshlrev_b32 v218, 16, v101
    v_and_b32 v219, 0xffff0000, v101
    v_lshlrev_b32 v220, 16, v102
    v_and_b32 v221, 0xffff0000, v102
    v_lshlrev_b32 v222, 16, v103
    v_and_b32 v223, 0xffff0000, v103
    v_pk_mul_f32 v[4:5], v[184:185], v[168:169]
    v_pk_mul_f32 v[6:7], v[186:187], v[170:171]
    v_pk_mul_f32 v[8:9], v[188:189], v[172:173]
    v_pk_mul_f32 v[10:11], v[190:191], v[174:175]
    v_pk_fma_f32 v[4:5], v[192:193], v[160:161], v[4:5]
    v_pk_fma_f32 v[6:7], v[194:195], v[162:163], v[6:7]
    v_pk_fma_f32 v[8:9], v[196:197], v[164:165], v[8:9]
    v_pk_fma_f32 v[10:11], v[198:199], v[166:167], v[10:11]
    v_pk_fma_f32 v[4:5], v[200:201], v[152:153], v[4:5]
    v_pk_fma_f32 v[6:7], v[202:203], v[154:155], v[6:7]
    v_pk_fma_f32 v[8:9], v[204:205], v[156:157], v[8:9]
    v_pk_fma_f32 v[10:11], v[206:207], v[158:159], v[10:11]
    v_pk_fma_f32 v[4:5], v[176:177], v[144:145], v[4:5]
    v_pk_fma_f32 v[6:7], v[178:179], v[146:147], v[6:7]
    v_pk_fma_f32 v[8:9], v[180:181], v[148:149], v[8:9]
    v_pk_fma_f32 v[10:11], v[182:183], v[150:151], v[10:11]
    v_pk_mul_f32 v[216:217], v[216:217], v[4:5]
    v_pk_mul_f32 v[218:219], v[218:219], v[6:7]
    v_pk_mul_f32 v[220:221], v[220:221], v[8:9]
    v_pk_mul_f32 v[222:223], v[222:223], v[10:11]
    v_cvt_pk_bf16_f32 v225, v216, v208
    v_cvt_pk_bf16_f32 v229, v217, v209
    v_cvt_pk_bf16_f32 v233, v218, v210
    v_cvt_pk_bf16_f32 v237, v219, v211
    v_cvt_pk_bf16_f32 v241, v220, v212
    v_cvt_pk_bf16_f32 v245, v221, v213
    v_cvt_pk_bf16_f32 v13, v222, v214
    v_cvt_pk_bf16_f32 v17, v223, v215
    s_movk_i32 s62, 0x4000
    buffer_load_dwordx4 v[48:51], v1, s[32:35], s62 offen offset:0
    buffer_load_dwordx4 v[112:115], v1, s[36:39], s62 offen offset:0
    s_waitcnt vmcnt(4)
    v_lshlrev_b32 v184, 16, v40
    v_and_b32 v185, 0xffff0000, v40
    v_lshlrev_b32 v186, 16, v41
    v_and_b32 v187, 0xffff0000, v41
    v_lshlrev_b32 v188, 16, v42
    v_and_b32 v189, 0xffff0000, v42
    v_lshlrev_b32 v190, 16, v43
    v_and_b32 v191, 0xffff0000, v43
    v_lshlrev_b32 v208, 16, v104
    v_and_b32 v209, 0xffff0000, v104
    v_lshlrev_b32 v210, 16, v105
    v_and_b32 v211, 0xffff0000, v105
    v_lshlrev_b32 v212, 16, v106
    v_and_b32 v213, 0xffff0000, v106
    v_lshlrev_b32 v214, 16, v107
    v_and_b32 v215, 0xffff0000, v107
    v_pk_mul_f32 v[4:5], v[192:193], v[168:169]
    v_pk_mul_f32 v[6:7], v[194:195], v[170:171]
    v_pk_mul_f32 v[8:9], v[196:197], v[172:173]
    v_pk_mul_f32 v[10:11], v[198:199], v[174:175]
    v_pk_fma_f32 v[4:5], v[200:201], v[160:161], v[4:5]
    v_pk_fma_f32 v[6:7], v[202:203], v[162:163], v[6:7]
    v_pk_fma_f32 v[8:9], v[204:205], v[164:165], v[8:9]
    v_pk_fma_f32 v[10:11], v[206:207], v[166:167], v[10:11]
    v_pk_fma_f32 v[4:5], v[176:177], v[152:153], v[4:5]
    v_pk_fma_f32 v[6:7], v[178:179], v[154:155], v[6:7]
    v_pk_fma_f32 v[8:9], v[180:181], v[156:157], v[8:9]
    v_pk_fma_f32 v[10:11], v[182:183], v[158:159], v[10:11]
    v_pk_fma_f32 v[4:5], v[184:185], v[144:145], v[4:5]
    v_pk_fma_f32 v[6:7], v[186:187], v[146:147], v[6:7]
    v_pk_fma_f32 v[8:9], v[188:189], v[148:149], v[8:9]
    v_pk_fma_f32 v[10:11], v[190:191], v[150:151], v[10:11]
    v_pk_mul_f32 v[208:209], v[208:209], v[4:5]
    v_pk_mul_f32 v[210:211], v[210:211], v[6:7]
    v_pk_mul_f32 v[212:213], v[212:213], v[8:9]
    v_pk_mul_f32 v[214:215], v[214:215], v[10:11]
    buffer_load_dwordx4 v[52:55], v1, s[32:35], s62 offen offset:2048
    buffer_load_dwordx4 v[116:119], v1, s[36:39], s62 offen offset:2048
    s_waitcnt vmcnt(4)
    v_lshlrev_b32 v192, 16, v44
    v_and_b32 v193, 0xffff0000, v44
    v_lshlrev_b32 v194, 16, v45
    v_and_b32 v195, 0xffff0000, v45
    v_lshlrev_b32 v196, 16, v46
    v_and_b32 v197, 0xffff0000, v46
    v_lshlrev_b32 v198, 16, v47
    v_and_b32 v199, 0xffff0000, v47
    v_lshlrev_b32 v216, 16, v108
    v_and_b32 v217, 0xffff0000, v108
    v_lshlrev_b32 v218, 16, v109
    v_and_b32 v219, 0xffff0000, v109
    v_lshlrev_b32 v220, 16, v110
    v_and_b32 v221, 0xffff0000, v110
    v_lshlrev_b32 v222, 16, v111
    v_and_b32 v223, 0xffff0000, v111
    v_pk_mul_f32 v[4:5], v[200:201], v[168:169]
    v_pk_mul_f32 v[6:7], v[202:203], v[170:171]
    v_pk_mul_f32 v[8:9], v[204:205], v[172:173]
    v_pk_mul_f32 v[10:11], v[206:207], v[174:175]
    v_pk_fma_f32 v[4:5], v[176:177], v[160:161], v[4:5]
    v_pk_fma_f32 v[6:7], v[178:179], v[162:163], v[6:7]
    v_pk_fma_f32 v[8:9], v[180:181], v[164:165], v[8:9]
    v_pk_fma_f32 v[10:11], v[182:183], v[166:167], v[10:11]
    v_pk_fma_f32 v[4:5], v[184:185], v[152:153], v[4:5]
    v_pk_fma_f32 v[6:7], v[186:187], v[154:155], v[6:7]
    v_pk_fma_f32 v[8:9], v[188:189], v[156:157], v[8:9]
    v_pk_fma_f32 v[10:11], v[190:191], v[158:159], v[10:11]
    v_pk_fma_f32 v[4:5], v[192:193], v[144:145], v[4:5]
    v_pk_fma_f32 v[6:7], v[194:195], v[146:147], v[6:7]
    v_pk_fma_f32 v[8:9], v[196:197], v[148:149], v[8:9]
    v_pk_fma_f32 v[10:11], v[198:199], v[150:151], v[10:11]
    v_pk_mul_f32 v[216:217], v[216:217], v[4:5]
    v_pk_mul_f32 v[218:219], v[218:219], v[6:7]
    v_pk_mul_f32 v[220:221], v[220:221], v[8:9]
    v_pk_mul_f32 v[222:223], v[222:223], v[10:11]
    v_cvt_pk_bf16_f32 v224, v216, v208
    v_cvt_pk_bf16_f32 v228, v217, v209
    v_cvt_pk_bf16_f32 v232, v218, v210
    v_cvt_pk_bf16_f32 v236, v219, v211
    v_cvt_pk_bf16_f32 v240, v220, v212
    v_cvt_pk_bf16_f32 v244, v221, v213
    v_cvt_pk_bf16_f32 v12, v222, v214
    v_cvt_pk_bf16_f32 v16, v223, v215
    ds_write_b128 v2, v[224:227] offset:0
    ds_write_b128 v2, v[228:231] offset:256
    ds_write_b128 v2, v[232:235] offset:512
    ds_write_b128 v2, v[236:239] offset:768
    ds_write_b128 v2, v[240:243] offset:1024
    ds_write_b128 v2, v[244:247] offset:1280
    ds_write_b128 v2, v[12:15] offset:1536
    ds_write_b128 v2, v[16:19] offset:1792
    s_waitcnt lgkmcnt(0)
    s_movk_i32 s62, 0x5000
    buffer_load_dwordx4 v[56:59], v1, s[32:35], s62 offen offset:0
    buffer_load_dwordx4 v[120:123], v1, s[36:39], s62 offen offset:0
    s_waitcnt vmcnt(4)
    v_lshlrev_b32 v200, 16, v48
    v_and_b32 v201, 0xffff0000, v48
    v_lshlrev_b32 v202, 16, v49
    v_and_b32 v203, 0xffff0000, v49
    v_lshlrev_b32 v204, 16, v50
    v_and_b32 v205, 0xffff0000, v50
    v_lshlrev_b32 v206, 16, v51
    v_and_b32 v207, 0xffff0000, v51
    v_lshlrev_b32 v208, 16, v112
    v_and_b32 v209, 0xffff0000, v112
    v_lshlrev_b32 v210, 16, v113
    v_and_b32 v211, 0xffff0000, v113
    v_lshlrev_b32 v212, 16, v114
    v_and_b32 v213, 0xffff0000, v114
    v_lshlrev_b32 v214, 16, v115
    v_and_b32 v215, 0xffff0000, v115
    v_pk_mul_f32 v[4:5], v[176:177], v[168:169]
    v_pk_mul_f32 v[6:7], v[178:179], v[170:171]
    v_pk_mul_f32 v[8:9], v[180:181], v[172:173]
    v_pk_mul_f32 v[10:11], v[182:183], v[174:175]
    v_pk_fma_f32 v[4:5], v[184:185], v[160:161], v[4:5]
    v_pk_fma_f32 v[6:7], v[186:187], v[162:163], v[6:7]
    v_pk_fma_f32 v[8:9], v[188:189], v[164:165], v[8:9]
    v_pk_fma_f32 v[10:11], v[190:191], v[166:167], v[10:11]
    v_pk_fma_f32 v[4:5], v[192:193], v[152:153], v[4:5]
    v_pk_fma_f32 v[6:7], v[194:195], v[154:155], v[6:7]
    v_pk_fma_f32 v[8:9], v[196:197], v[156:157], v[8:9]
    v_pk_fma_f32 v[10:11], v[198:199], v[158:159], v[10:11]
    v_pk_fma_f32 v[4:5], v[200:201], v[144:145], v[4:5]
    v_pk_fma_f32 v[6:7], v[202:203], v[146:147], v[6:7]
    v_pk_fma_f32 v[8:9], v[204:205], v[148:149], v[8:9]
    v_pk_fma_f32 v[10:11], v[206:207], v[150:151], v[10:11]
    v_pk_mul_f32 v[208:209], v[208:209], v[4:5]
    v_pk_mul_f32 v[210:211], v[210:211], v[6:7]
    v_pk_mul_f32 v[212:213], v[212:213], v[8:9]
    v_pk_mul_f32 v[214:215], v[214:215], v[10:11]
    buffer_load_dwordx4 v[60:63], v1, s[32:35], s62 offen offset:2048
    buffer_load_dwordx4 v[124:127], v1, s[36:39], s62 offen offset:2048
    s_waitcnt vmcnt(4)
    v_lshlrev_b32 v176, 16, v52
    v_and_b32 v177, 0xffff0000, v52
    v_lshlrev_b32 v178, 16, v53
    v_and_b32 v179, 0xffff0000, v53
    v_lshlrev_b32 v180, 16, v54
    v_and_b32 v181, 0xffff0000, v54
    v_lshlrev_b32 v182, 16, v55
    v_and_b32 v183, 0xffff0000, v55
    v_lshlrev_b32 v216, 16, v116
    v_and_b32 v217, 0xffff0000, v116
    v_lshlrev_b32 v218, 16, v117
    v_and_b32 v219, 0xffff0000, v117
    v_lshlrev_b32 v220, 16, v118
    v_and_b32 v221, 0xffff0000, v118
    v_lshlrev_b32 v222, 16, v119
    v_and_b32 v223, 0xffff0000, v119
    v_pk_mul_f32 v[4:5], v[184:185], v[168:169]
    v_pk_mul_f32 v[6:7], v[186:187], v[170:171]
    v_pk_mul_f32 v[8:9], v[188:189], v[172:173]
    v_pk_mul_f32 v[10:11], v[190:191], v[174:175]
    v_pk_fma_f32 v[4:5], v[192:193], v[160:161], v[4:5]
    v_pk_fma_f32 v[6:7], v[194:195], v[162:163], v[6:7]
    v_pk_fma_f32 v[8:9], v[196:197], v[164:165], v[8:9]
    v_pk_fma_f32 v[10:11], v[198:199], v[166:167], v[10:11]
    v_pk_fma_f32 v[4:5], v[200:201], v[152:153], v[4:5]
    v_pk_fma_f32 v[6:7], v[202:203], v[154:155], v[6:7]
    v_pk_fma_f32 v[8:9], v[204:205], v[156:157], v[8:9]
    v_pk_fma_f32 v[10:11], v[206:207], v[158:159], v[10:11]
    v_pk_fma_f32 v[4:5], v[176:177], v[144:145], v[4:5]
    v_pk_fma_f32 v[6:7], v[178:179], v[146:147], v[6:7]
    v_pk_fma_f32 v[8:9], v[180:181], v[148:149], v[8:9]
    v_pk_fma_f32 v[10:11], v[182:183], v[150:151], v[10:11]
    v_pk_mul_f32 v[216:217], v[216:217], v[4:5]
    v_pk_mul_f32 v[218:219], v[218:219], v[6:7]
    v_pk_mul_f32 v[220:221], v[220:221], v[8:9]
    v_pk_mul_f32 v[222:223], v[222:223], v[10:11]
    v_cvt_pk_bf16_f32 v227, v216, v208
    v_cvt_pk_bf16_f32 v231, v217, v209
    v_cvt_pk_bf16_f32 v235, v218, v210
    v_cvt_pk_bf16_f32 v239, v219, v211
    v_cvt_pk_bf16_f32 v243, v220, v212
    v_cvt_pk_bf16_f32 v247, v221, v213
    v_cvt_pk_bf16_f32 v15, v222, v214
    v_cvt_pk_bf16_f32 v19, v223, v215
    s_movk_i32 s62, 0x6000
    buffer_load_dwordx4 v[64:67], v1, s[32:35], s62 offen offset:0
    buffer_load_dwordx4 v[128:131], v1, s[36:39], s62 offen offset:0
    s_waitcnt vmcnt(4)
    v_lshlrev_b32 v184, 16, v56
    v_and_b32 v185, 0xffff0000, v56
    v_lshlrev_b32 v186, 16, v57
    v_and_b32 v187, 0xffff0000, v57
    v_lshlrev_b32 v188, 16, v58
    v_and_b32 v189, 0xffff0000, v58
    v_lshlrev_b32 v190, 16, v59
    v_and_b32 v191, 0xffff0000, v59
    v_lshlrev_b32 v208, 16, v120
    v_and_b32 v209, 0xffff0000, v120
    v_lshlrev_b32 v210, 16, v121
    v_and_b32 v211, 0xffff0000, v121
    v_lshlrev_b32 v212, 16, v122
    v_and_b32 v213, 0xffff0000, v122
    v_lshlrev_b32 v214, 16, v123
    v_and_b32 v215, 0xffff0000, v123
    v_pk_mul_f32 v[4:5], v[192:193], v[168:169]
    v_pk_mul_f32 v[6:7], v[194:195], v[170:171]
    v_pk_mul_f32 v[8:9], v[196:197], v[172:173]
    v_pk_mul_f32 v[10:11], v[198:199], v[174:175]
    v_pk_fma_f32 v[4:5], v[200:201], v[160:161], v[4:5]
    v_pk_fma_f32 v[6:7], v[202:203], v[162:163], v[6:7]
    v_pk_fma_f32 v[8:9], v[204:205], v[164:165], v[8:9]
    v_pk_fma_f32 v[10:11], v[206:207], v[166:167], v[10:11]
    v_pk_fma_f32 v[4:5], v[176:177], v[152:153], v[4:5]
    v_pk_fma_f32 v[6:7], v[178:179], v[154:155], v[6:7]
    v_pk_fma_f32 v[8:9], v[180:181], v[156:157], v[8:9]
    v_pk_fma_f32 v[10:11], v[182:183], v[158:159], v[10:11]
    v_pk_fma_f32 v[4:5], v[184:185], v[144:145], v[4:5]
    v_pk_fma_f32 v[6:7], v[186:187], v[146:147], v[6:7]
    v_pk_fma_f32 v[8:9], v[188:189], v[148:149], v[8:9]
    v_pk_fma_f32 v[10:11], v[190:191], v[150:151], v[10:11]
    v_pk_mul_f32 v[208:209], v[208:209], v[4:5]
    v_pk_mul_f32 v[210:211], v[210:211], v[6:7]
    v_pk_mul_f32 v[212:213], v[212:213], v[8:9]
    v_pk_mul_f32 v[214:215], v[214:215], v[10:11]
    buffer_load_dwordx4 v[68:71], v1, s[32:35], s62 offen offset:2048
    buffer_load_dwordx4 v[132:135], v1, s[36:39], s62 offen offset:2048
    s_waitcnt vmcnt(4)
    v_lshlrev_b32 v192, 16, v60
    v_and_b32 v193, 0xffff0000, v60
    v_lshlrev_b32 v194, 16, v61
    v_and_b32 v195, 0xffff0000, v61
    v_lshlrev_b32 v196, 16, v62
    v_and_b32 v197, 0xffff0000, v62
    v_lshlrev_b32 v198, 16, v63
    v_and_b32 v199, 0xffff0000, v63
    v_lshlrev_b32 v216, 16, v124
    v_and_b32 v217, 0xffff0000, v124
    v_lshlrev_b32 v218, 16, v125
    v_and_b32 v219, 0xffff0000, v125
    v_lshlrev_b32 v220, 16, v126
    v_and_b32 v221, 0xffff0000, v126
    v_lshlrev_b32 v222, 16, v127
    v_and_b32 v223, 0xffff0000, v127
    v_pk_mul_f32 v[4:5], v[200:201], v[168:169]
    v_pk_mul_f32 v[6:7], v[202:203], v[170:171]
    v_pk_mul_f32 v[8:9], v[204:205], v[172:173]
    v_pk_mul_f32 v[10:11], v[206:207], v[174:175]
    v_pk_fma_f32 v[4:5], v[176:177], v[160:161], v[4:5]
    v_pk_fma_f32 v[6:7], v[178:179], v[162:163], v[6:7]
    v_pk_fma_f32 v[8:9], v[180:181], v[164:165], v[8:9]
    v_pk_fma_f32 v[10:11], v[182:183], v[166:167], v[10:11]
    v_pk_fma_f32 v[4:5], v[184:185], v[152:153], v[4:5]
    v_pk_fma_f32 v[6:7], v[186:187], v[154:155], v[6:7]
    v_pk_fma_f32 v[8:9], v[188:189], v[156:157], v[8:9]
    v_pk_fma_f32 v[10:11], v[190:191], v[158:159], v[10:11]
    v_pk_fma_f32 v[4:5], v[192:193], v[144:145], v[4:5]
    v_pk_fma_f32 v[6:7], v[194:195], v[146:147], v[6:7]
    v_pk_fma_f32 v[8:9], v[196:197], v[148:149], v[8:9]
    v_pk_fma_f32 v[10:11], v[198:199], v[150:151], v[10:11]
    v_pk_mul_f32 v[216:217], v[216:217], v[4:5]
    v_pk_mul_f32 v[218:219], v[218:219], v[6:7]
    v_pk_mul_f32 v[220:221], v[220:221], v[8:9]
    v_pk_mul_f32 v[222:223], v[222:223], v[10:11]
    v_cvt_pk_bf16_f32 v226, v216, v208
    v_cvt_pk_bf16_f32 v230, v217, v209
    v_cvt_pk_bf16_f32 v234, v218, v210
    v_cvt_pk_bf16_f32 v238, v219, v211
    v_cvt_pk_bf16_f32 v242, v220, v212
    v_cvt_pk_bf16_f32 v246, v221, v213
    v_cvt_pk_bf16_f32 v14, v222, v214
    v_cvt_pk_bf16_f32 v18, v223, v215
    s_movk_i32 s62, 0x7000
    buffer_load_dwordx4 v[72:75], v1, s[32:35], s62 offen offset:0
    buffer_load_dwordx4 v[136:139], v1, s[36:39], s62 offen offset:0
    s_waitcnt vmcnt(4)
    v_lshlrev_b32 v200, 16, v64
    v_and_b32 v201, 0xffff0000, v64
    v_lshlrev_b32 v202, 16, v65
    v_and_b32 v203, 0xffff0000, v65
    v_lshlrev_b32 v204, 16, v66
    v_and_b32 v205, 0xffff0000, v66
    v_lshlrev_b32 v206, 16, v67
    v_and_b32 v207, 0xffff0000, v67
    v_lshlrev_b32 v208, 16, v128
    v_and_b32 v209, 0xffff0000, v128
    v_lshlrev_b32 v210, 16, v129
    v_and_b32 v211, 0xffff0000, v129
    v_lshlrev_b32 v212, 16, v130
    v_and_b32 v213, 0xffff0000, v130
    v_lshlrev_b32 v214, 16, v131
    v_and_b32 v215, 0xffff0000, v131
    v_pk_mul_f32 v[4:5], v[176:177], v[168:169]
    v_pk_mul_f32 v[6:7], v[178:179], v[170:171]
    v_pk_mul_f32 v[8:9], v[180:181], v[172:173]
    v_pk_mul_f32 v[10:11], v[182:183], v[174:175]
    v_pk_fma_f32 v[4:5], v[184:185], v[160:161], v[4:5]
    v_pk_fma_f32 v[6:7], v[186:187], v[162:163], v[6:7]
    v_pk_fma_f32 v[8:9], v[188:189], v[164:165], v[8:9]
    v_pk_fma_f32 v[10:11], v[190:191], v[166:167], v[10:11]
    v_pk_fma_f32 v[4:5], v[192:193], v[152:153], v[4:5]
    v_pk_fma_f32 v[6:7], v[194:195], v[154:155], v[6:7]
    v_pk_fma_f32 v[8:9], v[196:197], v[156:157], v[8:9]
    v_pk_fma_f32 v[10:11], v[198:199], v[158:159], v[10:11]
    v_pk_fma_f32 v[4:5], v[200:201], v[144:145], v[4:5]
    v_pk_fma_f32 v[6:7], v[202:203], v[146:147], v[6:7]
    v_pk_fma_f32 v[8:9], v[204:205], v[148:149], v[8:9]
    v_pk_fma_f32 v[10:11], v[206:207], v[150:151], v[10:11]
    v_pk_mul_f32 v[208:209], v[208:209], v[4:5]
    v_pk_mul_f32 v[210:211], v[210:211], v[6:7]
    v_pk_mul_f32 v[212:213], v[212:213], v[8:9]
    v_pk_mul_f32 v[214:215], v[214:215], v[10:11]
    buffer_load_dwordx4 v[76:79], v1, s[32:35], s62 offen offset:2048
    buffer_load_dwordx4 v[140:143], v1, s[36:39], s62 offen offset:2048
    s_mov_b64 s[28:29], s[86:87]
    s_mov_b32 s30, 0x100
    s_mov_b32 s31, 0x20000
    buffer_load_dword v250, v252, s[28:31], 0 offen sc1
    s_waitcnt vmcnt(5)
    v_lshlrev_b32 v176, 16, v68
    v_and_b32 v177, 0xffff0000, v68
    v_lshlrev_b32 v178, 16, v69
    v_and_b32 v179, 0xffff0000, v69
    v_lshlrev_b32 v180, 16, v70
    v_and_b32 v181, 0xffff0000, v70
    v_lshlrev_b32 v182, 16, v71
    v_and_b32 v183, 0xffff0000, v71
    v_lshlrev_b32 v216, 16, v132
    v_and_b32 v217, 0xffff0000, v132
    v_lshlrev_b32 v218, 16, v133
    v_and_b32 v219, 0xffff0000, v133
    v_lshlrev_b32 v220, 16, v134
    v_and_b32 v221, 0xffff0000, v134
    v_lshlrev_b32 v222, 16, v135
    v_and_b32 v223, 0xffff0000, v135
    v_pk_mul_f32 v[4:5], v[184:185], v[168:169]
    v_pk_mul_f32 v[6:7], v[186:187], v[170:171]
    v_pk_mul_f32 v[8:9], v[188:189], v[172:173]
    v_pk_mul_f32 v[10:11], v[190:191], v[174:175]
    v_pk_fma_f32 v[4:5], v[192:193], v[160:161], v[4:5]
    v_pk_fma_f32 v[6:7], v[194:195], v[162:163], v[6:7]
    v_pk_fma_f32 v[8:9], v[196:197], v[164:165], v[8:9]
    v_pk_fma_f32 v[10:11], v[198:199], v[166:167], v[10:11]
    v_pk_fma_f32 v[4:5], v[200:201], v[152:153], v[4:5]
    v_pk_fma_f32 v[6:7], v[202:203], v[154:155], v[6:7]
    v_pk_fma_f32 v[8:9], v[204:205], v[156:157], v[8:9]
    v_pk_fma_f32 v[10:11], v[206:207], v[158:159], v[10:11]
    v_pk_fma_f32 v[4:5], v[176:177], v[144:145], v[4:5]
    v_pk_fma_f32 v[6:7], v[178:179], v[146:147], v[6:7]
    v_pk_fma_f32 v[8:9], v[180:181], v[148:149], v[8:9]
    v_pk_fma_f32 v[10:11], v[182:183], v[150:151], v[10:11]
    v_pk_mul_f32 v[216:217], v[216:217], v[4:5]
    v_pk_mul_f32 v[218:219], v[218:219], v[6:7]
    v_pk_mul_f32 v[220:221], v[220:221], v[8:9]
    v_pk_mul_f32 v[222:223], v[222:223], v[10:11]
    v_cvt_pk_bf16_f32 v225, v216, v208
    v_cvt_pk_bf16_f32 v229, v217, v209
    v_cvt_pk_bf16_f32 v233, v218, v210
    v_cvt_pk_bf16_f32 v237, v219, v211
    v_cvt_pk_bf16_f32 v241, v220, v212
    v_cvt_pk_bf16_f32 v245, v221, v213
    v_cvt_pk_bf16_f32 v13, v222, v214
    v_cvt_pk_bf16_f32 v17, v223, v215
    s_waitcnt vmcnt(3)
    v_lshlrev_b32 v184, 16, v72
    v_and_b32 v185, 0xffff0000, v72
    v_lshlrev_b32 v186, 16, v73
    v_and_b32 v187, 0xffff0000, v73
    v_lshlrev_b32 v188, 16, v74
    v_and_b32 v189, 0xffff0000, v74
    v_lshlrev_b32 v190, 16, v75
    v_and_b32 v191, 0xffff0000, v75
    v_lshlrev_b32 v208, 16, v136
    v_and_b32 v209, 0xffff0000, v136
    v_lshlrev_b32 v210, 16, v137
    v_and_b32 v211, 0xffff0000, v137
    v_lshlrev_b32 v212, 16, v138
    v_and_b32 v213, 0xffff0000, v138
    v_lshlrev_b32 v214, 16, v139
    v_and_b32 v215, 0xffff0000, v139
    v_pk_mul_f32 v[4:5], v[192:193], v[168:169]
    v_pk_mul_f32 v[6:7], v[194:195], v[170:171]
    v_pk_mul_f32 v[8:9], v[196:197], v[172:173]
    v_pk_mul_f32 v[10:11], v[198:199], v[174:175]
    v_pk_fma_f32 v[4:5], v[200:201], v[160:161], v[4:5]
    v_pk_fma_f32 v[6:7], v[202:203], v[162:163], v[6:7]
    v_pk_fma_f32 v[8:9], v[204:205], v[164:165], v[8:9]
    v_pk_fma_f32 v[10:11], v[206:207], v[166:167], v[10:11]
    v_pk_fma_f32 v[4:5], v[176:177], v[152:153], v[4:5]
    v_pk_fma_f32 v[6:7], v[178:179], v[154:155], v[6:7]
    v_pk_fma_f32 v[8:9], v[180:181], v[156:157], v[8:9]
    v_pk_fma_f32 v[10:11], v[182:183], v[158:159], v[10:11]
    v_pk_fma_f32 v[4:5], v[184:185], v[144:145], v[4:5]
    v_pk_fma_f32 v[6:7], v[186:187], v[146:147], v[6:7]
    v_pk_fma_f32 v[8:9], v[188:189], v[148:149], v[8:9]
    v_pk_fma_f32 v[10:11], v[190:191], v[150:151], v[10:11]
    v_pk_mul_f32 v[208:209], v[208:209], v[4:5]
    v_pk_mul_f32 v[210:211], v[210:211], v[6:7]
    v_pk_mul_f32 v[212:213], v[212:213], v[8:9]
    v_pk_mul_f32 v[214:215], v[214:215], v[10:11]
    s_waitcnt vmcnt(1)
    v_lshlrev_b32 v192, 16, v76
    v_and_b32 v193, 0xffff0000, v76
    v_lshlrev_b32 v194, 16, v77
    v_and_b32 v195, 0xffff0000, v77
    v_lshlrev_b32 v196, 16, v78
    v_and_b32 v197, 0xffff0000, v78
    v_lshlrev_b32 v198, 16, v79
    v_and_b32 v199, 0xffff0000, v79
    v_lshlrev_b32 v216, 16, v140
    v_and_b32 v217, 0xffff0000, v140
    v_lshlrev_b32 v218, 16, v141
    v_and_b32 v219, 0xffff0000, v141
    v_lshlrev_b32 v220, 16, v142
    v_and_b32 v221, 0xffff0000, v142
    v_lshlrev_b32 v222, 16, v143
    v_and_b32 v223, 0xffff0000, v143
    v_pk_mul_f32 v[4:5], v[200:201], v[168:169]
    v_pk_mul_f32 v[6:7], v[202:203], v[170:171]
    v_pk_mul_f32 v[8:9], v[204:205], v[172:173]
    v_pk_mul_f32 v[10:11], v[206:207], v[174:175]
    v_pk_fma_f32 v[4:5], v[176:177], v[160:161], v[4:5]
    v_pk_fma_f32 v[6:7], v[178:179], v[162:163], v[6:7]
    v_pk_fma_f32 v[8:9], v[180:181], v[164:165], v[8:9]
    v_pk_fma_f32 v[10:11], v[182:183], v[166:167], v[10:11]
    v_pk_fma_f32 v[4:5], v[184:185], v[152:153], v[4:5]
    v_pk_fma_f32 v[6:7], v[186:187], v[154:155], v[6:7]
    v_pk_fma_f32 v[8:9], v[188:189], v[156:157], v[8:9]
    v_pk_fma_f32 v[10:11], v[190:191], v[158:159], v[10:11]
    v_pk_fma_f32 v[4:5], v[192:193], v[144:145], v[4:5]
    v_pk_fma_f32 v[6:7], v[194:195], v[146:147], v[6:7]
    v_pk_fma_f32 v[8:9], v[196:197], v[148:149], v[8:9]
    v_pk_fma_f32 v[10:11], v[198:199], v[150:151], v[10:11]
    v_pk_mul_f32 v[216:217], v[216:217], v[4:5]
    v_pk_mul_f32 v[218:219], v[218:219], v[6:7]
    v_pk_mul_f32 v[220:221], v[220:221], v[8:9]
    v_pk_mul_f32 v[222:223], v[222:223], v[10:11]
    v_cvt_pk_bf16_f32 v224, v216, v208
    v_cvt_pk_bf16_f32 v228, v217, v209
    v_cvt_pk_bf16_f32 v232, v218, v210
    v_cvt_pk_bf16_f32 v236, v219, v211
    v_cvt_pk_bf16_f32 v240, v220, v212
    v_cvt_pk_bf16_f32 v244, v221, v213
    v_cvt_pk_bf16_f32 v12, v222, v214
    v_cvt_pk_bf16_f32 v16, v223, v215
    ds_write_b128 v3, v[224:227] offset:0
    ds_write_b128 v3, v[228:231] offset:256
    ds_write_b128 v3, v[232:235] offset:512
    ds_write_b128 v3, v[236:239] offset:768
    ds_write_b128 v3, v[240:243] offset:1024
    ds_write_b128 v3, v[244:247] offset:1280
    ds_write_b128 v3, v[12:15] offset:1536
    ds_write_b128 v3, v[16:19] offset:1792
    s_waitcnt lgkmcnt(0)
    s_waitcnt vmcnt(0)
    v_readfirstlane_b32 s94, v250
    v_mov_b32 v251, 32
    s_nop 0
    s_cmp_ge_u32 s94, 32
    s_cbranch_scc1 L_cntok_13
    s_mov_b32 s51, 0
L_poll_14:
    buffer_load_dword v250, v252, s[28:31], 0 offen sc1
    s_waitcnt vmcnt(0)
    v_cmp_lt_u32 vcc, v250, v251
    s_add_u32 s51, s51, 1
    s_and_b32 s94, vcc_lo, 0x1
    s_cbranch_scc0 L_polldone_15
    s_sleep 32
    s_cmp_lt_u32 s51, 200000
    s_cbranch_scc1 L_poll_14
L_polldone_15:
L_cntok_13:
    s_cmp_lg_u32 s4, 0
    s_cbranch_scc1 L_prep_noid
    s_getreg_b32 s94, hwreg(HW_REG_XCC_ID, 0, 4)
    s_add_u32 s94, s94, 1
    v_mov_b32 v250, s94
    s_lshl_b32 s94, s5, 10
    s_add_u32 s94, s94, 0x2050300
    s_lshl_b32 s3, s6, 2
    s_add_u32 s94, s94, s3
    s_mov_b64 exec, 1
    buffer_store_dword v250, v252, s[20:23], s94 offen
    s_mov_b64 exec, -1
L_prep_noid:
    v_and_b32 v4, 15, v0
    v_lshrrev_b32 v5, 4, v0
    v_lshlrev_b32 v6, 4, v4
    v_lshl_add_u32 v1, v5, 12, v6
    v_lshl_add_u32 v6, v5, 8, v6
    v_add_u32 v6, s61, v6
    v_xor_b32 v8, 0, v6
    v_xor_b32 v9, 16, v6
    v_xor_b32 v10, 32, v6
    v_xor_b32 v11, 48, v6
    v_xor_b32 v12, 64, v6
    v_xor_b32 v13, 80, v6
    v_xor_b32 v14, 96, v6
    v_xor_b32 v15, 112, v6
    ds_read_b128 v[80:83], v8 offset:0
    ds_read_b128 v[84:87], v8 offset:1024
    ds_read_b128 v[88:91], v9 offset:2048
    ds_read_b128 v[92:95], v9 offset:3072
    ds_read_b128 v[96:99], v10 offset:4096
    ds_read_b128 v[100:103], v10 offset:5120
    ds_read_b128 v[104:107], v11 offset:6144
    ds_read_b128 v[108:111], v11 offset:7168
    ds_read_b128 v[112:115], v12 offset:8192
    ds_read_b128 v[116:119], v12 offset:9216
    ds_read_b128 v[120:123], v13 offset:10240
    ds_read_b128 v[124:127], v13 offset:11264
    ds_read_b128 v[128:131], v14 offset:12288
    ds_read_b128 v[132:135], v14 offset:13312
    ds_read_b128 v[136:139], v15 offset:14336
    ds_read_b128 v[140:143], v15 offset:15360
    s_lshl_b32 s59, s57, 18
    s_sub_u32 s60, 15, s58
    s_lshl_b32 s60, s60, 8
    s_add_u32 s59, s59, s60
    s_add_u32 s59, s59, 0x1000000
    s_waitcnt lgkmcnt(15)
    buffer_store_dwordx4 v[80:83], v1, s[20:23], s59 offen sc1
    s_add_u32 s59, s59, 0x4000
    s_waitcnt lgkmcnt(14)
    buffer_store_dwordx4 v[84:87], v1, s[20:23], s59 offen sc1
    s_add_u32 s59, s59, 0x4000
    s_waitcnt lgkmcnt(13)
    buffer_store_dwordx4 v[88:91], v1, s[20:23], s59 offen sc1
    s_add_u32 s59, s59, 0x4000
    s_waitcnt lgkmcnt(12)
    buffer_store_dwordx4 v[92:95], v1, s[20:23], s59 offen sc1
    s_add_u32 s59, s59, 0x4000
    s_waitcnt lgkmcnt(11)
    buffer_store_dwordx4 v[96:99], v1, s[20:23], s59 offen sc1
    s_add_u32 s59, s59, 0x4000
    s_waitcnt lgkmcnt(10)
    buffer_store_dwordx4 v[100:103], v1, s[20:23], s59 offen sc1
    s_add_u32 s59, s59, 0x4000
    s_waitcnt lgkmcnt(9)
    buffer_store_dwordx4 v[104:107], v1, s[20:23], s59 offen sc1
    s_add_u32 s59, s59, 0x4000
    s_waitcnt lgkmcnt(8)
    buffer_store_dwordx4 v[108:111], v1, s[20:23], s59 offen sc1
    s_add_u32 s59, s59, 0x4000
    s_waitcnt lgkmcnt(7)
    buffer_store_dwordx4 v[112:115], v1, s[20:23], s59 offen sc1
    s_add_u32 s59, s59, 0x4000
    s_waitcnt lgkmcnt(6)
    buffer_store_dwordx4 v[116:119], v1, s[20:23], s59 offen sc1
    s_add_u32 s59, s59, 0x4000
    s_waitcnt lgkmcnt(5)
    buffer_store_dwordx4 v[120:123], v1, s[20:23], s59 offen sc1
    s_add_u32 s59, s59, 0x4000
    s_waitcnt lgkmcnt(4)
    buffer_store_dwordx4 v[124:127], v1, s[20:23], s59 offen sc1
    s_add_u32 s59, s59, 0x4000
    s_waitcnt lgkmcnt(3)
    buffer_store_dwordx4 v[128:131], v1, s[20:23], s59 offen sc1
    s_add_u32 s59, s59, 0x4000
    s_waitcnt lgkmcnt(2)
    buffer_store_dwordx4 v[132:135], v1, s[20:23], s59 offen sc1
    s_add_u32 s59, s59, 0x4000
    s_waitcnt lgkmcnt(1)
    buffer_store_dwordx4 v[136:139], v1, s[20:23], s59 offen sc1
    s_add_u32 s59, s59, 0x4000
    s_waitcnt lgkmcnt(0)
    buffer_store_dwordx4 v[140:143], v1, s[20:23], s59 offen sc1
    s_add_u32 s59, s59, 0x4000
    s_lshl_b32 s58, s58, 4
    s_add_u32 s58, s58, s57
    s_lshl_b32 s58, s58, 10
    s_add_u32 s58, s58, 0x2040200
    s_waitcnt vmcnt(0)
    s_mov_b64 exec, 1
    buffer_store_dword v253, v252, s[20:23], s58 offen sc1
    s_mov_b64 exec, -1
    s_setprio 0
    s_cmp_lt_u32 s4, 4
    s_cbranch_scc1 L_csetup
    s_barrier
    s_setprio 1
    s_lshl_b32 s76, s5, 5
    s_add_u32 s76, s76, s6
    s_lshl_b32 s76, s76, 2
    s_add_u32 s76, s76, s7
    s_lshr_b32 s3, s76, 1
    s_lshl_b32 s3, s3, 2
    s_load_dword s93, s[74:75], s3
    s_lshl_b32 s3, s76, 12
    s_load_dword s51, s[72:73], s3
    v_lshlrev_b32 v1, 4, v0
    v_and_b32 v20, 31, v0
    v_lshlrev_b32 v20, 2, v20
    v_and_b32 v21, 15, v0
    v_lshlrev_b32 v21, 14, v21
    v_lshrrev_b32 v4, 4, v0
    v_and_b32 v2, 15, v0
    v_lshlrev_b32 v3, 1, v4
    v_xor_b32 v2, v2, v3
    v_lshlrev_b32 v2, 4, v2
    v_lshl_add_u32 v2, v4, 11, v2
    v_xor_b32 v3, 128, v2
    v_add_u32 v212, 0, v2
    v_add_u32 v213, 7168, v3
    v_add_u32 v214, 14336, v2
    v_add_u32 v215, 21504, v3
    v_and_b32 v2, 15, v0
    v_lshrrev_b32 v3, 4, v0
    s_lshl_b32 s94, s7, 14
    s_add_u32 s94, s94, 98304
    v_lshl_add_u32 v4, v3, 3, v2
    v_and_b32 v5, 1, v2
    v_add_u32 v6, v4, v5
    v_lshlrev_b32 v6, 1, v6
    v_xor_b32 v5, 1, v5
    v_mul_u32_u24 v5, 4160, v5
    v_add3_u32 v196, v6, v5, s94
    v_add_u32 v197, 1024, v196
    v_add_u32 v198, 2048, v196
    v_add_u32 v199, 3072, v196
    v_lshlrev_b32 v6, 4, v3
    v_lshlrev_b32 v5, 5, v2
    v_sub_u32 v6, v6, v5
    s_add_u32 s94, s94, 8800
    v_add_u32 v200, s94, v6
    v_and_b32 v201, 1, v3
    v_lshlrev_b32 v201, 9, v201
    v_lshrrev_b32 v5, 1, v3
    v_lshl_add_u32 v201, v5, 6, v201
    v_lshrrev_b32 v5, 2, v2
    v_lshl_add_u32 v201, v5, 7, v201
    v_and_b32 v5, 3, v0
    v_lshl_add_u32 v201, v5, 4, v201
    v_sub_u32 v4, 15, v4
    v_ashrrev_i32 v5, 1, v4
    v_and_b32 v4, 1, v4
    v_lshlrev_b32 v4, 4, v4
    s_waitcnt lgkmcnt(0)
    s_and_b32 s3, s76, 1
    s_lshl_b32 s3, s3, 4
    s_lshr_b32 s94, s93, s3
    s_and_b32 s94, s94, 0xffff
    v_lshlrev_b32 v4, v4, s94
    v_cmp_eq_u32 vcc, 0, v5
    s_nop 1
    v_cndmask_b32 v192, 0, v4, vcc
    v_cmp_eq_u32 vcc, 1, v5
    s_nop 1
    v_cndmask_b32 v193, 0, v4, vcc
    v_cmp_eq_u32 vcc, 2, v5
    s_nop 1
    v_cndmask_b32 v194, 0, v4, vcc
    v_cmp_eq_u32 vcc, 3, v5
    s_nop 1
    v_cndmask_b32 v195, 0, v4, vcc
    s_lshl_b32 s76, s76, 12
    s_add_u32 s76, s76, 0x1400000
    v_add_u32 v216, 12416, v1
    v_add_u32 v217, 2, v1
    s_movk_i32 s3, 0
    v_writelane_b32 v216, s3, 30
    s_movk_i32 s3, 16
    v_writelane_b32 v216, s3, 31
    s_movk_i32 s3, 4160
    v_writelane_b32 v216, s3, 32
    s_movk_i32 s3, 4176
    v_writelane_b32 v216, s3, 33
    s_lshl_b32 s94, s7, 14
    s_add_u32 s94, s94, 98304
    v_add_u32 v216, s94, v216
    v_add_u32 v217, s94, v1
    v_mov_b32 v220, 0
    v_mov_b32 v221, 0
    v_mov_b32 v222, 0
    v_mov_b32 v223, 0
    s_lshl_b32 s3, s51, 16
    v_writelane_b32 v223, s3, 33
    s_mov_b64 s[40:41], s[72:73]
    s_mov_b32 s42, 0x400000
    s_mov_b32 s43, 0x20000
    s_andn2_b32 s3, 1, s55
    s_mul_i32 s3, s3, 3
    s_add_u32 s3, s3, 0
    v_add_u32 v2, s3, v0
    v_subrev_u32 v3, 28, v2
    v_min_u32 v2, v2, v3
    s_lshr_b32 s3, s55, 1
    s_add_u32 s3, s54, s3
    v_add_u32 v3, s3, v2
    v_and_b32 v3, 3, v3
    v_and_b32 v2, 28, v2
    s_lshr_b32 s3, s54, 2
    s_mul_i32 s3, s3, 8
    v_add3_u32 v2, v2, v3, s3
    v_cmp_gt_u32 vcc, 28, v0
    v_subrev_u32 v3, 28, v2
    v_min_u32 v2, v2, v3
    v_cndmask_b32 v23, v0, v2, vcc
    s_mul_i32 s3, s56, 1
    s_lshl_b32 s52, s3, 1
    s_sub_u32 s52, 29, s52
    v_cmp_le_u32 vcc, s3, v23
    v_mov_b32 v3, 63
    s_nop 0
    v_mbcnt_lo_u32_b32 v2, vcc_lo, 0
    v_mbcnt_hi_u32_b32 v2, vcc_hi, v2
    v_cndmask_b32 v2, v3, v2, vcc
    v_lshlrev_b32 v2, 2, v2
    ds_permute_b32 v23, v2, v23
    s_waitcnt lgkmcnt(0)
    s_lshl_b32 s57, s5, 5
    s_add_u32 s57, s57, s6
    s_lshl_b32 s57, s57, 2
    s_add_u32 s57, s57, s7
    s_lshl_b32 s57, s57, 12
    s_lshl_b32 s58, s7, 14
    s_add_u32 s58, s58, 98304
    s_add_u32 m0, s58, 32
    s_mov_b32 exec_hi, 3
    ds_write_b128 v216, v[220:223]
    s_mov_b64 exec, -1
    buffer_load_dwordx4 v1, s[40:43], s57 offen offset:0 lds
    buffer_load_dwordx4 v1, s[40:43], s57 offen offset:1024 lds
    buffer_load_dwordx4 v1, s[40:43], s57 offen offset:2048 lds
    buffer_load_dwordx4 v1, s[40:43], s57 offen offset:3072 lds
    s_branch L_cv_wait
L_help_c:
    s_barrier
    s_mov_b64 s[44:45], s[82:83]
    s_mov_b32 s46, 0x800
    s_mov_b32 s47, 0x20000
    s_lshr_b32 s57, s2, 6
    s_lshl2_add_u32 s57, s5, s57
    s_lshl_b32 s58, s57, 2
    s_add_u32 s58, s58, s7
    s_lshl_b32 s59, s58, 15
    buffer_load_dwordx4 v[152:155], v1, s[44:47], 0 offen offset:0
    buffer_load_dwordx4 v[156:159], v1, s[44:47], 0 offen offset:1024
    buffer_load_dwordx4 v[16:19], v1, s[8:11], s59 offen offset:0
    buffer_load_dwordx4 v[20:23], v1, s[8:11], s59 offen offset:1024
    buffer_load_dwordx4 v[24:27], v1, s[8:11], s59 offen offset:2048
    buffer_load_dwordx4 v[28:31], v1, s[8:11], s59 offen offset:3072
    s_add_u32 s59, s59, 0x1000
    buffer_load_dwordx4 v[32:35], v1, s[8:11], s59 offen offset:0
    buffer_load_dwordx4 v[36:39], v1, s[8:11], s59 offen offset:1024
    buffer_load_dwordx4 v[40:43], v1, s[8:11], s59 offen offset:2048
    buffer_load_dwordx4 v[44:47], v1, s[8:11], s59 offen offset:3072
    s_add_u32 s59, s59, 0x1000
    buffer_load_dwordx4 v[48:51], v1, s[8:11], s59 offen offset:0
    buffer_load_dwordx4 v[52:55], v1, s[8:11], s59 offen offset:1024
    buffer_load_dwordx4 v[56:59], v1, s[8:11], s59 offen offset:2048
    buffer_load_dwordx4 v[60:63], v1, s[8:11], s59 offen offset:3072
    s_add_u32 s59, s59, 0x1000
    buffer_load_dwordx4 v[64:67], v1, s[8:11], s59 offen offset:0
    buffer_load_dwordx4 v[68:71], v1, s[8:11], s59 offen offset:1024
    buffer_load_dwordx4 v[72:75], v1, s[8:11], s59 offen offset:2048
    buffer_load_dwordx4 v[76:79], v1, s[8:11], s59 offen offset:3072
    s_add_u32 s59, s59, 0x1000
    buffer_load_dwordx4 v[80:83], v1, s[8:11], s59 offen offset:0
    buffer_load_dwordx4 v[84:87], v1, s[8:11], s59 offen offset:1024
    buffer_load_dwordx4 v[88:91], v1, s[8:11], s59 offen offset:2048
    buffer_load_dwordx4 v[92:95], v1, s[8:11], s59 offen offset:3072
    s_add_u32 s59, s59, 0x1000
    buffer_load_dwordx4 v[96:99], v1, s[8:11], s59 offen offset:0
    buffer_load_dwordx4 v[100:103], v1, s[8:11], s59 offen offset:1024
    buffer_load_dwordx4 v[104:107], v1, s[8:11], s59 offen offset:2048
    buffer_load_dwordx4 v[108:111], v1, s[8:11], s59 offen offset:3072
    s_add_u32 s59, s59, 0x1000
    v_and_b32 v3, 15, v0
    v_lshrrev_b32 v4, 4, v0
    v_lshlrev_b32 v4, 2, v4
    v_sub_u32 v3, v3, v4
    v_mov_b32 v2, 0
    v_cmp_eq_u32 vcc, 0, v3
    s_nop 1
    v_cndmask_b32 v176, 0, 1.0, vcc
    v_cmp_eq_u32 vcc, 1, v3
    s_nop 1
    v_cndmask_b32 v177, 0, 1.0, vcc
    v_cmp_eq_u32 vcc, 2, v3
    s_nop 1
    v_cndmask_b32 v178, 0, 1.0, vcc
    v_cmp_eq_u32 vcc, 3, v3
    s_nop 1
    v_cndmask_b32 v179, 0, 1.0, vcc
    s_waitcnt vmcnt(20)
    v_mfma_f32_16x16x32_bf16 v[180:183], v[152:155], v[16:19], 0
    v_mfma_f32_16x16x32_bf16 v[180:183], v[156:159], v[20:23], v[180:183]
    v_mfma_f32_16x16x32_bf16 v[184:187], v[152:155], v[24:27], 0
    v_mfma_f32_16x16x32_bf16 v[184:187], v[156:159], v[28:31], v[184:187]
    buffer_load_dwordx4 v[120:123], v1, s[8:11], s59 offen offset:0
    buffer_load_dwordx4 v[124:127], v1, s[8:11], s59 offen offset:1024
    buffer_load_dwordx4 v[128:131], v1, s[8:11], s59 offen offset:2048
    buffer_load_dwordx4 v[132:135], v1, s[8:11], s59 offen offset:3072
    s_add_u32 s59, s59, 0x1000
    s_waitcnt vmcnt(20)
    v_mfma_f32_16x16x32_bf16 v[188:191], v[152:155], v[32:35], 0
    v_mfma_f32_16x16x32_bf16 v[188:191], v[156:159], v[36:39], v[188:191]
    v_mfma_f32_16x16x32_bf16 v[192:195], v[152:155], v[40:43], 0
    v_mfma_f32_16x16x32_bf16 v[192:195], v[156:159], v[44:47], v[192:195]
    s_nop 3
    v_mul_f32 v160, v180, v176
    v_fmac_f32 v160, v181, v177
    v_fmac_f32 v160, v182, v178
    v_fmac_f32 v160, v183, v179
    v_mul_f32 v161, v184, v176
    v_fmac_f32 v161, v185, v177
    v_fmac_f32 v161, v186, v178
    v_fmac_f32 v161, v187, v179
    v_mul_f32 v162, v188, v176
    v_fmac_f32 v162, v189, v177
    v_fmac_f32 v162, v190, v178
    v_fmac_f32 v162, v191, v179
    v_mul_f32 v163, v192, v176
    v_fmac_f32 v163, v193, v177
    v_fmac_f32 v163, v194, v178
    v_fmac_f32 v163, v195, v179
    v_add_f32_dpp v160, v160, v160 row_shr:1
    v_add_f32_dpp v161, v161, v161 row_shr:1
    v_add_f32_dpp v162, v162, v162 row_shr:1
    v_add_f32_dpp v163, v163, v163 row_shr:1
    v_add_f32_dpp v160, v160, v160 row_shr:2
    v_add_f32_dpp v161, v161, v161 row_shr:2
    v_add_f32_dpp v162, v162, v162 row_shr:2
    v_add_f32_dpp v163, v163, v163 row_shr:2
    v_add_f32_dpp v160, v160, v160 row_shr:4
    v_add_f32_dpp v161, v161, v161 row_shr:4
    v_add_f32_dpp v162, v162, v162 row_shr:4
    v_add_f32_dpp v163, v163, v163 row_shr:4
    v_add_f32_dpp v160, v160, v160 row_shr:8
    v_add_f32_dpp v161, v161, v161 row_shr:8
    v_add_f32_dpp v162, v162, v162 row_shr:8
    v_add_f32_dpp v163, v163, v163 row_shr:8
    v_add_f32_dpp v160, v160, v160 row_bcast:15 row_mask:0xa
    v_add_f32_dpp v161, v161, v161 row_bcast:15 row_mask:0xa
    v_add_f32_dpp v162, v162, v162 row_bcast:15 row_mask:0xa
    v_add_f32_dpp v163, v163, v163 row_bcast:15 row_mask:0xa
    v_add_f32_dpp v160, v160, v160 row_bcast:31 row_mask:0xc
    v_add_f32_dpp v161, v161, v161 row_bcast:31 row_mask:0xc
    v_add_f32_dpp v162, v162, v162 row_bcast:31 row_mask:0xc
    v_add_f32_dpp v163, v163, v163 row_bcast:31 row_mask:0xc
    v_readlane_b32 s60, v160, 63
    v_readlane_b32 s61, v161, 63
    v_readlane_b32 s62, v162, 63
    v_readlane_b32 s63, v163, 63
    s_nop 1
    v_writelane_b32 v2, s60, 0
    v_writelane_b32 v2, s61, 1
    v_writelane_b32 v2, s62, 2
    v_writelane_b32 v2, s63, 3
    buffer_load_dwordx4 v[136:139], v1, s[8:11], s59 offen offset:0
    buffer_load_dwordx4 v[140:143], v1, s[8:11], s59 offen offset:1024
    buffer_load_dwordx4 v[144:147], v1, s[8:11], s59 offen offset:2048
    buffer_load_dwordx4 v[148:151], v1, s[8:11], s59 offen offset:3072
    s_add_u32 s59, s59, 0x1000
    s_waitcnt vmcnt(20)
    v_mfma_f32_16x16x32_bf16 v[180:183], v[152:155], v[48:51], 0
    v_mfma_f32_16x16x32_bf16 v[180:183], v[156:159], v[52:55], v[180:183]
    v_mfma_f32_16x16x32_bf16 v[184:187], v[152:155], v[56:59], 0
    v_mfma_f32_16x16x32_bf16 v[184:187], v[156:159], v[60:63], v[184:187]
    s_waitcnt vmcnt(16)
    v_mfma_f32_16x16x32_bf16 v[188:191], v[152:155], v[64:67], 0
    v_mfma_f32_16x16x32_bf16 v[188:191], v[156:159], v[68:71], v[188:191]
    v_mfma_f32_16x16x32_bf16 v[192:195], v[152:155], v[72:75], 0
    v_mfma_f32_16x16x32_bf16 v[192:195], v[156:159], v[76:79], v[192:195]
    s_nop 3
    v_mul_f32 v160, v180, v176
    v_fmac_f32 v160, v181, v177
    v_fmac_f32 v160, v182, v178
    v_fmac_f32 v160, v183, v179
    v_mul_f32 v161, v184, v176
    v_fmac_f32 v161, v185, v177
    v_fmac_f32 v161, v186, v178
    v_fmac_f32 v161, v187, v179
    v_mul_f32 v162, v188, v176
    v_fmac_f32 v162, v189, v177
    v_fmac_f32 v162, v190, v178
    v_fmac_f32 v162, v191, v179
    v_mul_f32 v163, v192, v176
    v_fmac_f32 v163, v193, v177
    v_fmac_f32 v163, v194, v178
    v_fmac_f32 v163, v195, v179
    v_add_f32_dpp v160, v160, v160 row_shr:1
    v_add_f32_dpp v161, v161, v161 row_shr:1
    v_add_f32_dpp v162, v162, v162 row_shr:1
    v_add_f32_dpp v163, v163, v163 row_shr:1
    v_add_f32_dpp v160, v160, v160 row_shr:2
    v_add_f32_dpp v161, v161, v161 row_shr:2
    v_add_f32_dpp v162, v162, v162 row_shr:2
    v_add_f32_dpp v163, v163, v163 row_shr:2
    v_add_f32_dpp v160, v160, v160 row_shr:4
    v_add_f32_dpp v161, v161, v161 row_shr:4
    v_add_f32_dpp v162, v162, v162 row_shr:4
    v_add_f32_dpp v163, v163, v163 row_shr:4
    v_add_f32_dpp v160, v160, v160 row_shr:8
    v_add_f32_dpp v161, v161, v161 row_shr:8
    v_add_f32_dpp v162, v162, v162 row_shr:8
    v_add_f32_dpp v163, v163, v163 row_shr:8
    v_add_f32_dpp v160, v160, v160 row_bcast:15 row_mask:0xa
    v_add_f32_dpp v161, v161, v161 row_bcast:15 row_mask:0xa
    v_add_f32_dpp v162, v162, v162 row_bcast:15 row_mask:0xa
    v_add_f32_dpp v163, v163, v163 row_bcast:15 row_mask:0xa
    v_add_f32_dpp v160, v160, v160 row_bcast:31 row_mask:0xc
    v_add_f32_dpp v161, v161, v161 row_bcast:31 row_mask:0xc
    v_add_f32_dpp v162, v162, v162 row_bcast:31 row_mask:0xc
    v_add_f32_dpp v163, v163, v163 row_bcast:31 row_mask:0xc
    v_readlane_b32 s60, v160, 63
    v_readlane_b32 s61, v161, 63
    v_readlane_b32 s62, v162, 63
    v_readlane_b32 s63, v163, 63
    s_nop 1
    v_writelane_b32 v2, s60, 4
    v_writelane_b32 v2, s61, 5
    v_writelane_b32 v2, s62, 6
    v_writelane_b32 v2, s63, 7
    s_waitcnt vmcnt(12)
    v_mfma_f32_16x16x32_bf16 v[180:183], v[152:155], v[80:83], 0
    v_mfma_f32_16x16x32_bf16 v[180:183], v[156:159], v[84:87], v[180:183]
    v_mfma_f32_16x16x32_bf16 v[184:187], v[152:155], v[88:91], 0
    v_mfma_f32_16x16x32_bf16 v[184:187], v[156:159], v[92:95], v[184:187]
    s_waitcnt vmcnt(8)
    v_mfma_f32_16x16x32_bf16 v[188:191], v[152:155], v[96:99], 0
    v_mfma_f32_16x16x32_bf16 v[188:191], v[156:159], v[100:103], v[188:191]
    v_mfma_f32_16x16x32_bf16 v[192:195], v[152:155], v[104:107], 0
    v_mfma_f32_16x16x32_bf16 v[192:195], v[156:159], v[108:111], v[192:195]
    s_nop 3
    v_mul_f32 v160, v180, v176
    v_fmac_f32 v160, v181, v177
    v_fmac_f32 v160, v182, v178
    v_fmac_f32 v160, v183, v179
    v_mul_f32 v161, v184, v176
    v_fmac_f32 v161, v185, v177
    v_fmac_f32 v161, v186, v178
    v_fmac_f32 v161, v187, v179
    v_mul_f32 v162, v188, v176
    v_fmac_f32 v162, v189, v177
    v_fmac_f32 v162, v190, v178
    v_fmac_f32 v162, v191, v179
    v_mul_f32 v163, v192, v176
    v_fmac_f32 v163, v193, v177
    v_fmac_f32 v163, v194, v178
    v_fmac_f32 v163, v195, v179
    v_add_f32_dpp v160, v160, v160 row_shr:1
    v_add_f32_dpp v161, v161, v161 row_shr:1
    v_add_f32_dpp v162, v162, v162 row_shr:1
    v_add_f32_dpp v163, v163, v163 row_shr:1
    v_add_f32_dpp v160, v160, v160 row_shr:2
    v_add_f32_dpp v161, v161, v161 row_shr:2
    v_add_f32_dpp v162, v162, v162 row_shr:2
    v_add_f32_dpp v163, v163, v163 row_shr:2
    v_add_f32_dpp v160, v160, v160 row_shr:4
    v_add_f32_dpp v161, v161, v161 row_shr:4
    v_add_f32_dpp v162, v162, v162 row_shr:4
    v_add_f32_dpp v163, v163, v163 row_shr:4
    v_add_f32_dpp v160, v160, v160 row_shr:8
    v_add_f32_dpp v161, v161, v161 row_shr:8
    v_add_f32_dpp v162, v162, v162 row_shr:8
    v_add_f32_dpp v163, v163, v163 row_shr:8
    v_add_f32_dpp v160, v160, v160 row_bcast:15 row_mask:0xa
    v_add_f32_dpp v161, v161, v161 row_bcast:15 row_mask:0xa
    v_add_f32_dpp v162, v162, v162 row_bcast:15 row_mask:0xa
    v_add_f32_dpp v163, v163, v163 row_bcast:15 row_mask:0xa
    v_add_f32_dpp v160, v160, v160 row_bcast:31 row_mask:0xc
    v_add_f32_dpp v161, v161, v161 row_bcast:31 row_mask:0xc
    v_add_f32_dpp v162, v162, v162 row_bcast:31 row_mask:0xc
    v_add_f32_dpp v163, v163, v163 row_bcast:31 row_mask:0xc
    v_readlane_b32 s60, v160, 63
    v_readlane_b32 s61, v161, 63
    v_readlane_b32 s62, v162, 63
    v_readlane_b32 s63, v163, 63
    s_nop 1
    v_writelane_b32 v2, s60, 8
    v_writelane_b32 v2, s61, 9
    v_writelane_b32 v2, s62, 10
    v_writelane_b32 v2, s63, 11
    s_waitcnt vmcnt(4)
    v_mfma_f32_16x16x32_bf16 v[180:183], v[152:155], v[120:123], 0
    v_mfma_f32_16x16x32_bf16 v[180:183], v[156:159], v[124:127], v[180:183]
    v_mfma_f32_16x16x32_bf16 v[184:187], v[152:155], v[128:131], 0
    v_mfma_f32_16x16x32_bf16 v[184:187], v[156:159], v[132:135], v[184:187]
    s_waitcnt vmcnt(0)
    v_mfma_f32_16x16x32_bf16 v[188:191], v[152:155], v[136:139], 0
    v_mfma_f32_16x16x32_bf16 v[188:191], v[156:159], v[140:143], v[188:191]
    v_mfma_f32_16x16x32_bf16 v[192:195], v[152:155], v[144:147], 0
    v_mfma_f32_16x16x32_bf16 v[192:195], v[156:159], v[148:151], v[192:195]
    buffer_load_dword v15, v14, s[20:23], 0 offen sc1
    s_nop 3
    v_mul_f32 v160, v180, v176
    v_fmac_f32 v160, v181, v177
    v_fmac_f32 v160, v182, v178
    v_fmac_f32 v160, v183, v179
    v_mul_f32 v161, v184, v176
    v_fmac_f32 v161, v185, v177
    v_fmac_f32 v161, v186, v178
    v_fmac_f32 v161, v187, v179
    v_mul_f32 v162, v188, v176
    v_fmac_f32 v162, v189, v177
    v_fmac_f32 v162, v190, v178
    v_fmac_f32 v162, v191, v179
    v_mul_f32 v163, v192, v176
    v_fmac_f32 v163, v193, v177
    v_fmac_f32 v163, v194, v178
    v_fmac_f32 v163, v195, v179
    v_add_f32_dpp v160, v160, v160 row_shr:1
    v_add_f32_dpp v161, v161, v161 row_shr:1
    v_add_f32_dpp v162, v162, v162 row_shr:1
    v_add_f32_dpp v163, v163, v163 row_shr:1
    v_add_f32_dpp v160, v160, v160 row_shr:2
    v_add_f32_dpp v161, v161, v161 row_shr:2
    v_add_f32_dpp v162, v162, v162 row_shr:2
    v_add_f32_dpp v163, v163, v163 row_shr:2
    v_add_f32_dpp v160, v160, v160 row_shr:4
    v_add_f32_dpp v161, v161, v161 row_shr:4
    v_add_f32_dpp v162, v162, v162 row_shr:4
    v_add_f32_dpp v163, v163, v163 row_shr:4
    v_add_f32_dpp v160, v160, v160 row_shr:8
    v_add_f32_dpp v161, v161, v161 row_shr:8
    v_add_f32_dpp v162, v162, v162 row_shr:8
    v_add_f32_dpp v163, v163, v163 row_shr:8
    v_add_f32_dpp v160, v160, v160 row_bcast:15 row_mask:0xa
    v_add_f32_dpp v161, v161, v161 row_bcast:15 row_mask:0xa
    v_add_f32_dpp v162, v162, v162 row_bcast:15 row_mask:0xa
    v_add_f32_dpp v163, v163, v163 row_bcast:15 row_mask:0xa
    v_add_f32_dpp v160, v160, v160 row_bcast:31 row_mask:0xc
    v_add_f32_dpp v161, v161, v161 row_bcast:31 row_mask:0xc
    v_add_f32_dpp v162, v162, v162 row_bcast:31 row_mask:0xc
    v_add_f32_dpp v163, v163, v163 row_bcast:31 row_mask:0xc
    v_readlane_b32 s60, v160, 63
    v_readlane_b32 s61, v161, 63
    v_readlane_b32 s62, v162, 63
    v_readlane_b32 s63, v163, 63
    s_nop 1
    v_writelane_b32 v2, s60, 12
    v_writelane_b32 v2, s61, 13
    v_writelane_b32 v2, s62, 14
    v_writelane_b32 v2, s63, 15
    v_cvt_pk_bf16_f32 v2, 0, v2
    v_mul_f32 v2, 0xbfb8aa3b, v2
    v_exp_f32 v2, v2
    s_nop 0
    v_add_f32 v2, 1.0, v2
    v_rcp_f32 v2, v2
    s_nop 0
    v_cvt_pk_bf16_f32 v4, 0, v2
    v_sub_f32 v2, 1.0, v4
    v_cvt_pk_bf16_f32 v5, 0, v2
    s_lshl_b32 s58, s58, 7
    s_add_u32 s58, s58, 0x2000000
    v_lshlrev_b32 v3, 3, v0
    s_mov_b64 exec, 0xffff
    buffer_store_dwordx2 v[4:5], v3, s[20:23], s58 offen sc1
    s_mov_b64 exec, -1
    s_mov_b64 s[16:17], s[80:81]
    s_mov_b32 s18, 0x700000
    s_mov_b32 s19, 0x20000
    s_mul_i32 s57, s54, 917504
    s_mul_i32 s3, s56, 458752
    s_add_u32 s57, s57, s3
    s_lshl_b32 s63, s7, 12
    s_add_u32 s57, s57, s63
    s_mul_i32 s58, s56, 3670016
    s_lshl_b32 s3, s55, 8
    s_add_u32 s58, s58, s3
    s_lshl_b32 s3, s7, 15
    s_add_u32 s58, s58, s3
    s_mov_b32 s59, 0
    s_lshl_b32 s3, s95, 2
    s_lshl_b32 s98, 15, s3
    s_and_b32 s98, s98, 0xfffffff
    v_readlane_b32 s93, v118, s59
    s_add_u32 s59, s59, 1
    s_bitset1_b32 s98, s93
    s_lshl_b32 s60, s93, 14
    s_add_u32 s60, s60, s57
    s_lshl_b32 s61, s93, 17
    s_add_u32 s61, s61, s58
    v_readlane_b32 s93, v118, s59
    s_add_u32 s59, s59, 1
    s_bitset1_b32 s98, s93
    s_lshl_b32 s90, s93, 14
    s_add_u32 s90, s90, s57
    s_lshl_b32 s62, s93, 17
    s_add_u32 s62, s62, s58
    v_readlane_b32 s93, v118, s59
    s_add_u32 s59, s59, 1
    s_bitset1_b32 s98, s93
    s_lshl_b32 s91, s93, 14
    s_add_u32 s91, s91, s57
    s_lshl_b32 s92, s93, 17
    s_add_u32 s92, s92, s58
    s_add_u32 m0, s63, 16384
    s_nop 0
    buffer_load_dwordx4 v248, s[16:19], s62 offen offset:0 lds
    buffer_load_dwordx4 v249, s[16:19], s62 offen offset:1024 lds
    buffer_load_dwordx4 v250, s[16:19], s62 offen offset:2048 lds
    buffer_load_dwordx4 v251, s[16:19], s62 offen offset:3072 lds
    s_waitcnt vmcnt(5)
    v_cmp_eq_u32 vcc, 1, v15
    s_nop 0
    s_bcnt1_i32_b32 s3, vcc_lo
    s_cmp_ge_u32 s3, 1
    s_cbranch_scc1 L_g2_c
    v_lshrrev_b32 v16, 1, v0
    v_lshlrev_b32 v19, 10, v16
    v_and_b32 v17, 1, v0
    v_lshl_add_u32 v16, v17, 7, v19
    s_lshr_b32 s94, s54, 2
    s_lshl_b32 s94, s94, 3
    s_and_b32 s3, s54, 3
    s_add_u32 s94, s94, s3
    s_add_u32 s51, s94, 4
    s_sub_u32 s3, s51, 28
    s_cselect_b32 s51, s51, s3
    s_lshl_b32 s51, s51, 17
    s_add_u32 s51, s51, s58
    s_sub_u32 s51, s51, 1792
    buffer_load_dword v18, v16, s[16:19], s51 offen offset:256
    buffer_load_dword v18, v16, s[16:19], s51 offen offset:768
    s_lshl2_add_u32 s3, s54, s7
    s_add_u32 s3, s3, 1792
    s_lshl_b32 s3, s3, 11
    v_and_b32 v17, 31, v0
    v_lshlrev_b32 v17, 6, v17
    buffer_load_dword v18, v17, s[16:19], s3 offen
    s_branch L_g2_c
L_fin:
L_end:
    s_endpgm
.section .rodata,"a"
.p2align 6
.amdhsa_kernel gated_mix__ssm_conv_h3__dense_activation_relu__prompt_kernel
  .amdhsa_next_free_vgpr 256
  .amdhsa_next_free_sgpr 102
  .amdhsa_accum_offset 256
  .amdhsa_group_segment_fixed_size 0
  .amdhsa_kernarg_size 104
  .amdhsa_user_sgpr_count 2
  .amdhsa_user_sgpr_kernarg_segment_ptr 1
  .amdhsa_system_sgpr_workgroup_id_x 1
  .amdhsa_float_denorm_mode_32 3
.end_amdhsa_kernel
```
